```python
import torch

def _softmax(x, axis=-1):
    return torch.softmax(x, dim=axis)
def _gelu(x):
    return torch.nn.functional.gelu(x, approximate="tanh")
def _silu(x):
    return torch.nn.functional.silu(x)
def _sigmoid(x):
    return torch.sigmoid(x)
def _layernorm(x, axis=-1, eps=1e-5):
    m = x.mean(dim=axis, keepdim=True)
    v = x.var(dim=axis, keepdim=True, unbiased=False)
    return (x - m) / torch.sqrt(v + eps)
def _scatter_add(tgt, idx, src, axis=0):
    return tgt.clone().index_add_(axis, idx, src)
def _segment_sum(src, seg, n):
    out = torch.zeros((n,) + src.shape[1:], dtype=src.dtype)
    return out.index_add_(0, seg, src)
def _pad(x, pw):
    flat = tuple(v for pair in reversed(pw) for v in pair)
    return torch.nn.functional.pad(x, flat)

kernel_name = 'gated_mix__mha_block__dense_activation_silu__prompt'

def setup_inputs():

    _w = (lambda a: (lambda t: t.to(torch.bfloat16) if t.is_floating_point() else t)(torch.as_tensor(a)))
    def _A_setup():
        B, S, D, H = 1, 2048, 512, 32
        return {
            "x": _w((lambda *s: torch.randn(*s, dtype=torch.bfloat16) * 0.05)(B, S, D)),
            "wqkv": _w((lambda *s: torch.randn(*s, dtype=torch.bfloat16) * 0.8)(D, 3 * D)),
            "wo": _w((lambda *s: torch.randn(*s, dtype=torch.bfloat16) * 0.05)(D, D)),
        }
    _A_in = _A_setup()

    def _B_setup():
        B, S, D, F = 1, 2048, 512, 1376
        return {
            "x": _w((lambda *s: torch.randn(*s, dtype=torch.bfloat16) * 0.05)(B, S, D)),
            "w1": _w((lambda *s: torch.randn(*s, dtype=torch.bfloat16) * 3.2)(D, F) * (D ** -0.5)),
            "w2": _w((lambda *s: torch.randn(*s, dtype=torch.bfloat16) * 0.8)(F, D) * (F ** -0.5)),
        }
    _B_in = _B_setup()

    return {
        "A_x": _A_in["x"],
        "A_wqkv": _A_in["wqkv"],
        "A_wo": _A_in["wo"],
        "B_x": _B_in["x"],
        "B_w1": _B_in["w1"],
        "B_w2": _B_in["w2"],
        "gate_w": _w((lambda *s: torch.randn(*s, dtype=torch.bfloat16) * 0.05)(512) * 16.0),
    }

def reference(A_x, A_wqkv, A_wo, B_x, B_w1, B_w2, gate_w):
    def _A_ref(x, wqkv, wo):
        B, S, D = x.shape
        H = 32
        Dh = D // H
        qkv = (lambda x, *d: x.permute(*d))((x @ wqkv).reshape(B, S, 3, H, Dh), 2, 0, 3, 1, 4)
        q, k, v = qkv[0], qkv[1], qkv[2]
        scores = torch.einsum("bhqd,bhkd->bhqk", q, k) * (Dh ** -0.5)
        p = _softmax(scores, axis=-1)
        o = torch.einsum("bhqk,bhkd->bhqd", p, v)
        return (lambda x, *d: x.permute(*d))(o, 0, 2, 1, 3).reshape(B, S, D) @ wo

    def _B_ref(x, w1, w2):
        h = torch.einsum("bsd,df->bsf", x, w1)
        h = _silu(h)
        out = torch.einsum("bsf,fd->bsd", h, w2)
        return out

    x = A_x
    g = _sigmoid((x * gate_w).sum(-1, keepdims=True))
    a = _A_ref(x, A_wqkv, A_wo)
    b = _B_ref(x, B_w1, B_w2)
    return g * a + (1 - g) * b
```

```asm
; @launch grid=(256,1,1) block=(512,1,1) lds=163840
.amdgcn_target "amdgcn-amd-amdhsa--gfx950"
.text
.globl gated_mix__mha_block__dense_activation_silu__prompt_kernel
.p2align 8
.type gated_mix__mha_block__dense_activation_silu__prompt_kernel,@function
gated_mix__mha_block__dense_activation_silu__prompt_kernel:
    s_load_dwordx16 s[64:79], s[0:1], 0
    s_load_dwordx4 s[80:83], s[0:1], 64
    s_cmp_ge_u32 s2, 256
    s_cbranch_scc1 L_end
    v_lshrrev_b32 v3, 6, v0
    v_and_b32 v1, 63, v0
    v_readfirstlane_b32 s46, v3
    s_and_b32 s44, s2, 6
    s_bfe_u32 s48, s2, 0x10003
    s_or_b32 s44, s44, s48
    s_and_b32 s45, s2, 1
    s_lshl_b32 s45, s45, 4
    s_lshr_b32 s88, s2, 4
    s_or_b32 s45, s45, s88
    v_lshlrev_b32 v2, 4, v1
    v_lshlrev_b32 v252, 2, v1
    v_lshrrev_b32 v3, 4, v1
    s_and_b32 s57, s46, 1
    s_lshr_b32 s56, s46, 1
    s_lshl_b32 s48, s57, 2
    v_or_b32 v3, s48, v3
    v_and_b32 v4, 7, v1
    v_xor_b32 v3, v3, v4
    v_lshlrev_b32 v3, 4, v3
    v_lshrrev_b32 v4, 3, v1
    v_lshl_add_u32 v3, v4, 10, v3
    s_lshl_b32 s48, s45, 16
    s_lshl_b32 s49, s46, 13
    s_add_u32 s48, s48, s49
    v_add_u32 v224, s48, v3
    s_lshl_b32 s54, s46, 10
    s_add_u32 s54, s54, 98304
    s_mul_i32 s55, s46, 3072
    s_mul_i32 s48, s44, 11
    s_min_u32 s60, s48, 76
    s_cmp_lt_u32 s44, 6
    s_cselect_b32 s61, 11, 10
    s_cmp_eq_u32 s46, 7
    s_cbranch_scc1 L_t_code
    s_cmp_ge_u32 s46, 2
    s_cbranch_scc1 L_t_none
    v_min_u32 v3, 47, v1
    v_mul_u32_u24 v4, 21846, v3
    v_lshrrev_b32 v4, 16, v4
    v_mul_u32_u24 v5, 3, v4
    v_sub_u32 v3, v3, v5
    v_lshlrev_b32 v3, 10, v3
    v_mul_u32_u24 v4, 3072, v4
    s_mul_i32 s48, s88, 2
    s_add_u32 s48, s48, s46
    s_mul_i32 s48, s48, 49152
    s_lshl_b32 s49, s44, 7
    s_add_u32 s48, s48, s49
    v_add3_u32 v3, v3, v4, s48
    s_waitcnt lgkmcnt(0)
    s_mov_b32 s8, s66
    s_mov_b32 s9, s67
    s_mov_b32 s10, 1572864
    s_mov_b32 s11, 0x20000
    buffer_load_dword v250, v3, s[8:11], 0 offen
    s_branch L_t_done
L_t_code:
    s_getpc_b64 s[100:101]
L_pc:
    s_lshr_b32 s48, s2, 3
    s_lshl_b32 s48, s48, 10
    v_and_b32 v3, 7, v1
    v_lshlrev_b32 v3, 7, v3
    v_add_u32 v3, s48, v3
    v_min_u32 v3, L_code_end-L_pc-4, v3
    s_mov_b64 exec, 0xff
    global_load_dword v250, v3, s[100:101]
    s_mov_b64 exec, -1
L_t_none:
    s_waitcnt lgkmcnt(0)
L_t_done:
    s_mov_b32 s12, s72
    s_mov_b32 s13, s73
    s_mov_b32 s14, 1409024
    s_mov_b32 s15, 0x20000
    s_mov_b32 s4, s64
    s_mov_b32 s5, s65
    s_mov_b32 s6, 2097152
    s_mov_b32 s7, 0x20000
    s_add_u32 m0, s54, 0
    s_movk_i32 s51, 0
    buffer_load_dwordx4 v224, s[4:7], s51 offen  lds
    s_add_u32 m0, s54, 8192
    s_movk_i32 s51, 128
    buffer_load_dwordx4 v224, s[4:7], s51 offen  lds
    s_mov_b32 s8, s66
    s_mov_b32 s9, s67
    s_mov_b32 s10, 1572864
    s_mov_b32 s11, 0x20000
    s_mov_b32 s32, s76
    s_mov_b32 s33, s77
    s_mov_b32 s34, 1024
    s_mov_b32 s35, 0x20000
    s_mov_b32 s28, s82
    s_mov_b32 s29, s83
    s_mov_b32 s30, 13631488
    s_mov_b32 s31, 0x20000
    s_lshl_b32 s96, s45, 1
    s_add_u32 s96, s96, s57
    s_lshl_b32 s96, s96, 5
    s_lshl_b32 s51, s44, 2
    s_add_u32 s96, s96, s51
    s_add_u32 s96, s96, s56
    s_lshl_b32 s96, s96, 10
    s_add_u32 s96, s96, 5242880
    v_mov_b32 v216, -1
    v_mov_b32 v217, -1
    v_mov_b32 v218, -1
    v_mov_b32 v219, -1
    s_lshl_b32 s50, s57, 2
    s_mul_i32 s48, s46, 24576
    s_lshl_b32 s49, s44, 7
    s_add_u32 s48, s48, s49
    v_add_u32 v3, 0, v1
    v_mul_u32_u24 v228, 2731, v3
    v_lshrrev_b32 v228, 16, v228
    v_mul_u32_u24 v4, 24, v228
    v_sub_u32 v3, v3, v4
    v_and_b32 v4, 2, v228
    v_or_b32 v4, s50, v4
    v_xor_b32 v84, v3, v4
    v_lshrrev_b32 v3, 3, v84
    v_lshlrev_b32 v3, 10, v3
    v_and_b32 v4, 7, v84
    v_lshl_add_u32 v3, v4, 4, v3
    v_mul_u32_u24 v4, 3072, v228
    v_add3_u32 v225, v3, v4, s48
    v_add_u32 v3, 64, v1
    v_mul_u32_u24 v229, 2731, v3
    v_lshrrev_b32 v229, 16, v229
    v_mul_u32_u24 v4, 24, v229
    v_sub_u32 v3, v3, v4
    v_and_b32 v4, 2, v229
    v_or_b32 v4, s50, v4
    v_xor_b32 v85, v3, v4
    v_lshrrev_b32 v3, 3, v85
    v_lshlrev_b32 v3, 10, v3
    v_and_b32 v4, 7, v85
    v_lshl_add_u32 v3, v4, 4, v3
    v_mul_u32_u24 v4, 3072, v229
    v_add3_u32 v226, v3, v4, s48
    v_add_u32 v3, 128, v1
    v_mul_u32_u24 v230, 2731, v3
    v_lshrrev_b32 v230, 16, v230
    v_mul_u32_u24 v4, 24, v230
    v_sub_u32 v3, v3, v4
    v_and_b32 v4, 2, v230
    v_or_b32 v4, s50, v4
    v_xor_b32 v86, v3, v4
    v_lshrrev_b32 v3, 3, v86
    v_lshlrev_b32 v3, 10, v3
    v_and_b32 v4, 7, v86
    v_lshl_add_u32 v3, v4, 4, v3
    v_mul_u32_u24 v4, 3072, v230
    v_add3_u32 v227, v3, v4, s48
    s_mov_b32 s16, s74
    s_mov_b32 s17, s75
    s_mov_b32 s18, 1409024
    s_mov_b32 s19, 0x20000
    s_mov_b32 s20, s68
    s_mov_b32 s21, s69
    s_mov_b32 s22, 524288
    s_mov_b32 s23, 0x20000
    s_mov_b32 s24, s78
    s_mov_b32 s25, s79
    s_mov_b32 s26, 2097152
    s_mov_b32 s27, 0x20000
    s_mul_i32 s48, s46, 22016
    s_lshl_b32 s49, s60, 5
    s_add_u32 s48, s48, s49
    s_lshl_b32 s49, s61, 1
    v_mul_u32_u24 v228, 2752, v228
    v_lshl_add_u32 v228, v84, 4, v228
    v_add_u32 v228, s48, v228
    v_cmp_gt_u32 vcc, s49, v84
    v_mov_b32 v3, 1073741824
    s_nop 0
    v_cndmask_b32 v228, v3, v228, vcc
    v_mul_u32_u24 v229, 2752, v229
    v_lshl_add_u32 v229, v85, 4, v229
    v_add_u32 v229, s48, v229
    v_cmp_gt_u32 vcc, s49, v85
    v_mov_b32 v3, 1073741824
    s_nop 0
    v_cndmask_b32 v229, v3, v229, vcc
    v_mul_u32_u24 v230, 2752, v230
    v_lshl_add_u32 v230, v86, 4, v230
    v_add_u32 v230, s48, v230
    v_cmp_gt_u32 vcc, s49, v86
    v_mov_b32 v3, 1073741824
    s_nop 0
    v_cndmask_b32 v230, v3, v230, vcc
    v_and_b32 v3, 15, v1
    v_lshrrev_b32 v4, 4, v1
    v_lshrrev_b32 v5, 1, v3
    v_xor_b32 v5, v5, v4
    v_lshlrev_b32 v5, 4, v5
    v_lshl_add_u32 v5, v3, 7, v5
    s_lshl_b32 s48, s57, 12
    s_add_u32 s48, s48, 98304
    v_add_u32 v231, s48, v5
    v_xor_b32 v232, 64, v231
    v_lshrrev_b32 v5, 2, v3
    v_lshl_add_u32 v5, v4, 3, v5
    v_mul_u32_u24 v5, 384, v5
    v_and_b32 v84, 3, v3
    v_lshl_add_u32 v5, v84, 3, v5
    v_lshrrev_b32 v84, 3, v3
    v_and_b32 v85, 1, v4
    v_lshl_add_u32 v84, v85, 1, v84
    v_xor_b32 v85, s56, v84
    v_lshl_add_u32 v233, v85, 5, v5
    v_add_u32 v234, 49152, v233
    s_mul_i32 s48, s56, 3
    s_add_u32 s49, s48, 0
    v_xor_b32 v85, s49, v84
    v_lshl_add_u32 v235, v85, 5, v5
    v_add_u32 v236, 49152, v235
    s_add_u32 s49, s48, 1
    v_xor_b32 v85, s49, v84
    v_lshl_add_u32 v237, v85, 5, v5
    v_add_u32 v238, 49152, v237
    s_add_u32 s49, s48, 2
    v_xor_b32 v85, s49, v84
    v_lshl_add_u32 v239, v85, 5, v5
    v_add_u32 v240, 49152, v239
    v_lshrrev_b32 v5, 5, v1
    v_lshlrev_b32 v5, 8, v5
    v_lshl_add_u32 v6, v3, 4, v5
    s_mov_b32 s52, 0xffff
    s_mov_b32 s53, 0xffff
    s_bfe_u32 s48, s2, 0x20003
    s_and_b32 s62, s2, 7
    s_lshl_b32 s62, s62, 2
    s_add_u32 s62, s62, s48
    s_lshr_b32 s63, s2, 5
    v_lshrrev_b32 v5, 4, v1
    v_and_b32 v5, 1, v5
    v_lshlrev_b32 v5, 2, v5
    v_and_b32 v84, 7, v1
    v_xor_b32 v5, v5, v84
    v_lshlrev_b32 v5, 4, v5
    v_lshrrev_b32 v84, 3, v1
    v_lshl_add_u32 v5, v84, 10, v5
    s_lshl_b32 s48, s46, 13
    s_lshl_b32 s49, s63, 7
    s_add_u32 s48, s48, s49
    v_add_u32 v241, s48, v5
    v_lshrrev_b32 v5, 2, v3
    v_lshlrev_b32 v5, 7, v5
    v_and_b32 v84, 1, v4
    v_lshl_add_u32 v5, v84, 5, v5
    v_and_b32 v84, 3, v3
    v_lshl_add_u32 v5, v84, 3, v5
    v_lshrrev_b32 v84, 3, v3
    v_lshl_add_u32 v5, v84, 6, v5
    s_lshl_b32 s48, s56, 11
    v_add_u32 v5, s48, v5
    v_lshrrev_b32 v84, 5, v1
    v_lshl_add_u32 v242, v84, 10, v5
    v_xor_b32 v243, 64, v242
    v_lshl_add_u32 v244, v84, 9, v5
    v_xor_b32 v245, 64, v244
    s_add_u32 m0, s55, 0
    s_mov_b32 s51, 0
    buffer_load_dwordx4 v225, s[8:11], s51 offen lds
    s_add_u32 m0, s55, 1024
    s_mov_b32 s51, 0
    buffer_load_dwordx4 v226, s[8:11], s51 offen lds
    s_add_u32 m0, s55, 2048
    s_mov_b32 s51, 0
    buffer_load_dwordx4 v227, s[8:11], s51 offen lds
    s_add_u32 m0, s54, 16384
    s_movk_i32 s51, 256
    buffer_load_dwordx4 v224, s[4:7], s51 offen  lds
    s_add_u32 m0, s54, 24576
    s_movk_i32 s51, 384
    buffer_load_dwordx4 v224, s[4:7], s51 offen  lds
    s_add_u32 m0, s54, 32768
    s_movk_i32 s51, 512
    buffer_load_dwordx4 v224, s[4:7], s51 offen  lds
    s_add_u32 m0, s54, 40960
    s_movk_i32 s51, 640
    buffer_load_dwordx4 v224, s[4:7], s51 offen  lds
    s_add_u32 m0, s54, 49152
    s_movk_i32 s51, 768
    buffer_load_dwordx4 v224, s[4:7], s51 offen  lds
    s_add_u32 m0, s54, 57344
    s_movk_i32 s51, 896
    buffer_load_dwordx4 v224, s[4:7], s51 offen  lds
    buffer_load_dwordx4 v[76:79], v2, s[32:35], 0 offen
    v_mov_b32 v3, 0
    buffer_load_dword v251, v3, s[28:31], 0 offen sc1
    buffer_store_dwordx4 v[216:219], v2, s[28:31], s96 offen sc1
    v_and_b32 v3, 3, v1
    v_lshlrev_b32 v3, 7, v3
    v_min_u32 v3, 348, v3
    v_lshrrev_b32 v4, 2, v1
    v_mul_u32_u24 v4, 2752, v4
    s_lshl_b32 s48, s88, 3
    s_add_u32 s48, s48, s46
    s_mul_i32 s48, s48, 11008
    s_lshl_b32 s49, s60, 5
    s_add_u32 s48, s48, s49
    v_add3_u32 v3, v3, v4, s48
    s_mov_b64 exec, 65535
    buffer_load_dword v250, v3, s[12:15], 0 offen
    s_mov_b64 exec, -1
    s_barrier
    s_add_u32 m0, s55, 24576
    s_mov_b32 s51, 196608
    buffer_load_dwordx4 v225, s[8:11], s51 offen lds
    s_add_u32 m0, s55, 25600
    s_mov_b32 s51, 196608
    buffer_load_dwordx4 v226, s[8:11], s51 offen lds
    s_add_u32 m0, s55, 26624
    s_mov_b32 s51, 196608
    buffer_load_dwordx4 v227, s[8:11], s51 offen lds
    s_waitcnt vmcnt(7)
    s_barrier
    ds_read_b128 v[88:91], v231 offset:0
    ds_read_b128 v[92:95], v231 offset:2048
    ds_read_b64_tr_b16 v[40:41], v233 offset:0
    ds_read_b64_tr_b16 v[42:43], v233 offset:1536
    ds_read_b64_tr_b16 v[44:45], v233 offset:128
    ds_read_b64_tr_b16 v[46:47], v233 offset:1664
    ds_read_b64_tr_b16 v[48:49], v233 offset:256
    ds_read_b64_tr_b16 v[50:51], v233 offset:1792
    s_waitcnt lgkmcnt(4)
    v_mfma_f32_16x16x32_bf16 v[16:19], v[40:43], v[88:91], 0
    ds_read_b128 v[96:99], v232 offset:0
    ds_read_b128 v[100:103], v232 offset:2048
    ds_read_b64_tr_b16 v[52:53], v233 offset:12288
    ds_read_b64_tr_b16 v[54:55], v233 offset:13824
    v_mfma_f32_16x16x32_bf16 v[20:23], v[40:43], v[92:95], 0
    s_add_u32 m0, s55, 49152
    s_mov_b32 s51, 393216
    buffer_load_dwordx4 v225, s[8:11], s51 offen lds
    s_waitcnt lgkmcnt(6)
    v_mfma_f32_16x16x32_bf16 v[24:27], v[44:47], v[88:91], 0
    ds_read_b64_tr_b16 v[56:57], v233 offset:12416
    ds_read_b64_tr_b16 v[58:59], v233 offset:13952
    v_mfma_f32_16x16x32_bf16 v[28:31], v[44:47], v[92:95], 0
    s_add_u32 m0, s55, 50176
    s_mov_b32 s51, 393216
    buffer_load_dwordx4 v226, s[8:11], s51 offen lds
    s_waitcnt lgkmcnt(6)
    v_mfma_f32_16x16x32_bf16 v[32:35], v[88:91], v[48:51], 0
    ds_read_b64_tr_b16 v[60:61], v233 offset:12544
    ds_read_b64_tr_b16 v[62:63], v233 offset:14080
    v_mfma_f32_16x16x32_bf16 v[36:39], v[92:95], v[48:51], 0
    s_add_u32 m0, s55, 51200
    s_mov_b32 s51, 393216
    buffer_load_dwordx4 v227, s[8:11], s51 offen lds
    s_waitcnt vmcnt(3)
    s_barrier
    v_readfirstlane_b32 s47, v251
    s_nop 3
    s_add_u32 s47, s47, 1
    s_waitcnt lgkmcnt(4)
    v_mfma_f32_16x16x32_bf16 v[16:19], v[52:55], v[96:99], v[16:19]
    ds_read_b128 v[104:107], v231 offset:8192
    ds_read_b128 v[108:111], v231 offset:10240
    ds_read_b64_tr_b16 v[40:41], v233 offset:24576
    ds_read_b64_tr_b16 v[42:43], v233 offset:26112
    v_mfma_f32_16x16x32_bf16 v[20:23], v[52:55], v[100:103], v[20:23]
    s_add_u32 m0, s55, 73728
    s_mov_b32 s51, 589824
    buffer_load_dwordx4 v225, s[8:11], s51 offen lds
    s_waitcnt lgkmcnt(6)
    v_mfma_f32_16x16x32_bf16 v[24:27], v[56:59], v[96:99], v[24:27]
    ds_read_b64_tr_b16 v[44:45], v233 offset:24704
    ds_read_b64_tr_b16 v[46:47], v233 offset:26240
    v_mfma_f32_16x16x32_bf16 v[28:31], v[56:59], v[100:103], v[28:31]
    s_add_u32 m0, s55, 74752
    s_mov_b32 s51, 589824
    buffer_load_dwordx4 v226, s[8:11], s51 offen lds
    s_waitcnt lgkmcnt(6)
    v_mfma_f32_16x16x32_bf16 v[32:35], v[96:99], v[60:63], v[32:35]
    ds_read_b64_tr_b16 v[48:49], v233 offset:24832
    ds_read_b64_tr_b16 v[50:51], v233 offset:26368
    v_mfma_f32_16x16x32_bf16 v[36:39], v[100:103], v[60:63], v[36:39]
    s_add_u32 m0, s55, 75776
    s_mov_b32 s51, 589824
    buffer_load_dwordx4 v227, s[8:11], s51 offen lds
    s_waitcnt lgkmcnt(4)
    v_mfma_f32_16x16x32_bf16 v[16:19], v[40:43], v[104:107], v[16:19]
    ds_read_b128 v[112:115], v232 offset:8192
    ds_read_b128 v[116:119], v232 offset:10240
    ds_read_b64_tr_b16 v[52:53], v233 offset:36864
    ds_read_b64_tr_b16 v[54:55], v233 offset:38400
    v_mfma_f32_16x16x32_bf16 v[20:23], v[40:43], v[108:111], v[20:23]
    s_waitcnt lgkmcnt(6)
    v_mfma_f32_16x16x32_bf16 v[24:27], v[44:47], v[104:107], v[24:27]
    ds_read_b64_tr_b16 v[56:57], v233 offset:36992
    ds_read_b64_tr_b16 v[58:59], v233 offset:38528
    v_mfma_f32_16x16x32_bf16 v[28:31], v[44:47], v[108:111], v[28:31]
    s_waitcnt lgkmcnt(6)
    v_mfma_f32_16x16x32_bf16 v[32:35], v[104:107], v[48:51], v[32:35]
    ds_read_b64_tr_b16 v[60:61], v233 offset:37120
    ds_read_b64_tr_b16 v[62:63], v233 offset:38656
    v_mfma_f32_16x16x32_bf16 v[36:39], v[108:111], v[48:51], v[36:39]
    s_waitcnt vmcnt(3)
    s_barrier
    s_waitcnt lgkmcnt(4)
    v_mfma_f32_16x16x32_bf16 v[16:19], v[52:55], v[112:115], v[16:19]
    ds_read_b128 v[120:123], v231 offset:16384
    ds_read_b128 v[124:127], v231 offset:18432
    ds_read_b64_tr_b16 v[40:41], v234 offset:0
    ds_read_b64_tr_b16 v[42:43], v234 offset:1536
    v_mfma_f32_16x16x32_bf16 v[20:23], v[52:55], v[116:119], v[20:23]
    s_add_u32 m0, s55, 0
    s_mov_b32 s51, 786432
    buffer_load_dwordx4 v225, s[8:11], s51 offen lds
    s_waitcnt lgkmcnt(6)
    v_mfma_f32_16x16x32_bf16 v[24:27], v[56:59], v[112:115], v[24:27]
    ds_read_b64_tr_b16 v[44:45], v234 offset:128
    ds_read_b64_tr_b16 v[46:47], v234 offset:1664
    v_mfma_f32_16x16x32_bf16 v[28:31], v[56:59], v[116:119], v[28:31]
    s_add_u32 m0, s55, 1024
    s_mov_b32 s51, 786432
    buffer_load_dwordx4 v226, s[8:11], s51 offen lds
    s_waitcnt lgkmcnt(6)
    v_mfma_f32_16x16x32_bf16 v[32:35], v[112:115], v[60:63], v[32:35]
    ds_read_b64_tr_b16 v[48:49], v234 offset:256
    ds_read_b64_tr_b16 v[50:51], v234 offset:1792
    v_mfma_f32_16x16x32_bf16 v[36:39], v[116:119], v[60:63], v[36:39]
    s_add_u32 m0, s55, 2048
    s_mov_b32 s51, 786432
    buffer_load_dwordx4 v227, s[8:11], s51 offen lds
    s_waitcnt lgkmcnt(4)
    v_mfma_f32_16x16x32_bf16 v[16:19], v[40:43], v[120:123], v[16:19]
    ds_read_b128 v[128:131], v232 offset:16384
    ds_read_b128 v[132:135], v232 offset:18432
    ds_read_b64_tr_b16 v[52:53], v234 offset:12288
    ds_read_b64_tr_b16 v[54:55], v234 offset:13824
    v_mfma_f32_16x16x32_bf16 v[20:23], v[40:43], v[124:127], v[20:23]
    s_waitcnt lgkmcnt(6)
    v_mfma_f32_16x16x32_bf16 v[24:27], v[44:47], v[120:123], v[24:27]
    ds_read_b64_tr_b16 v[56:57], v234 offset:12416
    ds_read_b64_tr_b16 v[58:59], v234 offset:13952
    v_mfma_f32_16x16x32_bf16 v[28:31], v[44:47], v[124:127], v[28:31]
    s_waitcnt lgkmcnt(6)
    v_mfma_f32_16x16x32_bf16 v[32:35], v[120:123], v[48:51], v[32:35]
    ds_read_b64_tr_b16 v[60:61], v234 offset:12544
    ds_read_b64_tr_b16 v[62:63], v234 offset:14080
    v_mfma_f32_16x16x32_bf16 v[36:39], v[124:127], v[48:51], v[36:39]
    s_waitcnt vmcnt(3)
    s_barrier
    s_waitcnt lgkmcnt(4)
    v_mfma_f32_16x16x32_bf16 v[16:19], v[52:55], v[128:131], v[16:19]
    ds_read_b128 v[136:139], v231 offset:24576
    ds_read_b128 v[140:143], v231 offset:26624
    ds_read_b64_tr_b16 v[40:41], v234 offset:24576
    ds_read_b64_tr_b16 v[42:43], v234 offset:26112
    v_mfma_f32_16x16x32_bf16 v[20:23], v[52:55], v[132:135], v[20:23]
    s_add_u32 m0, s55, 24576
    s_mov_b32 s51, 983040
    buffer_load_dwordx4 v225, s[8:11], s51 offen lds
    s_waitcnt lgkmcnt(6)
    v_mfma_f32_16x16x32_bf16 v[24:27], v[56:59], v[128:131], v[24:27]
    ds_read_b64_tr_b16 v[44:45], v234 offset:24704
    ds_read_b64_tr_b16 v[46:47], v234 offset:26240
    v_mfma_f32_16x16x32_bf16 v[28:31], v[56:59], v[132:135], v[28:31]
    s_add_u32 m0, s55, 25600
    s_mov_b32 s51, 983040
    buffer_load_dwordx4 v226, s[8:11], s51 offen lds
    s_waitcnt lgkmcnt(6)
    v_mfma_f32_16x16x32_bf16 v[32:35], v[128:131], v[60:63], v[32:35]
    ds_read_b64_tr_b16 v[48:49], v234 offset:24832
    ds_read_b64_tr_b16 v[50:51], v234 offset:26368
    v_mfma_f32_16x16x32_bf16 v[36:39], v[132:135], v[60:63], v[36:39]
    s_add_u32 m0, s55, 26624
    s_mov_b32 s51, 983040
    buffer_load_dwordx4 v227, s[8:11], s51 offen lds
    s_waitcnt lgkmcnt(4)
    v_mfma_f32_16x16x32_bf16 v[16:19], v[40:43], v[136:139], v[16:19]
    ds_read_b128 v[144:147], v232 offset:24576
    ds_read_b128 v[148:151], v232 offset:26624
    ds_read_b64_tr_b16 v[52:53], v234 offset:36864
    ds_read_b64_tr_b16 v[54:55], v234 offset:38400
    v_mfma_f32_16x16x32_bf16 v[20:23], v[40:43], v[140:143], v[20:23]
    s_waitcnt lgkmcnt(6)
    v_mfma_f32_16x16x32_bf16 v[24:27], v[44:47], v[136:139], v[24:27]
    ds_read_b64_tr_b16 v[56:57], v234 offset:36992
    ds_read_b64_tr_b16 v[58:59], v234 offset:38528
    v_mfma_f32_16x16x32_bf16 v[28:31], v[44:47], v[140:143], v[28:31]
    s_waitcnt lgkmcnt(6)
    v_mfma_f32_16x16x32_bf16 v[32:35], v[136:139], v[48:51], v[32:35]
    ds_read_b64_tr_b16 v[60:61], v234 offset:37120
    ds_read_b64_tr_b16 v[62:63], v234 offset:38656
    v_mfma_f32_16x16x32_bf16 v[36:39], v[140:143], v[48:51], v[36:39]
    s_waitcnt vmcnt(3)
    s_barrier
    s_waitcnt lgkmcnt(4)
    v_mfma_f32_16x16x32_bf16 v[16:19], v[52:55], v[144:147], v[16:19]
    ds_read_b128 v[152:155], v231 offset:32768
    ds_read_b128 v[156:159], v231 offset:34816
    ds_read_b64_tr_b16 v[40:41], v233 offset:0
    ds_read_b64_tr_b16 v[42:43], v233 offset:1536
    v_mfma_f32_16x16x32_bf16 v[20:23], v[52:55], v[148:151], v[20:23]
    s_add_u32 m0, s55, 49152
    s_mov_b32 s51, 1179648
    buffer_load_dwordx4 v225, s[8:11], s51 offen lds
    s_waitcnt lgkmcnt(6)
    v_mfma_f32_16x16x32_bf16 v[24:27], v[56:59], v[144:147], v[24:27]
    ds_read_b64_tr_b16 v[44:45], v233 offset:128
    ds_read_b64_tr_b16 v[46:47], v233 offset:1664
    v_mfma_f32_16x16x32_bf16 v[28:31], v[56:59], v[148:151], v[28:31]
    s_add_u32 m0, s55, 50176
    s_mov_b32 s51, 1179648
    buffer_load_dwordx4 v226, s[8:11], s51 offen lds
    s_waitcnt lgkmcnt(6)
    v_mfma_f32_16x16x32_bf16 v[32:35], v[144:147], v[60:63], v[32:35]
    ds_read_b64_tr_b16 v[48:49], v233 offset:256
    ds_read_b64_tr_b16 v[50:51], v233 offset:1792
    v_mfma_f32_16x16x32_bf16 v[36:39], v[148:151], v[60:63], v[36:39]
    s_add_u32 m0, s55, 51200
    s_mov_b32 s51, 1179648
    buffer_load_dwordx4 v227, s[8:11], s51 offen lds
    s_waitcnt lgkmcnt(4)
    v_mfma_f32_16x16x32_bf16 v[16:19], v[40:43], v[152:155], v[16:19]
    ds_read_b128 v[160:163], v232 offset:32768
    ds_read_b128 v[164:167], v232 offset:34816
    ds_read_b64_tr_b16 v[52:53], v233 offset:12288
    ds_read_b64_tr_b16 v[54:55], v233 offset:13824
    v_mfma_f32_16x16x32_bf16 v[20:23], v[40:43], v[156:159], v[20:23]
    s_waitcnt lgkmcnt(6)
    v_mfma_f32_16x16x32_bf16 v[24:27], v[44:47], v[152:155], v[24:27]
    ds_read_b64_tr_b16 v[56:57], v233 offset:12416
    ds_read_b64_tr_b16 v[58:59], v233 offset:13952
    v_mfma_f32_16x16x32_bf16 v[28:31], v[44:47], v[156:159], v[28:31]
    s_waitcnt lgkmcnt(6)
    v_mfma_f32_16x16x32_bf16 v[32:35], v[152:155], v[48:51], v[32:35]
    ds_read_b64_tr_b16 v[60:61], v233 offset:12544
    ds_read_b64_tr_b16 v[62:63], v233 offset:14080
    v_mfma_f32_16x16x32_bf16 v[36:39], v[156:159], v[48:51], v[36:39]
    s_waitcnt vmcnt(3)
    s_barrier
    s_waitcnt lgkmcnt(4)
    v_mfma_f32_16x16x32_bf16 v[16:19], v[52:55], v[160:163], v[16:19]
    ds_read_b128 v[168:171], v231 offset:40960
    ds_read_b128 v[172:175], v231 offset:43008
    ds_read_b64_tr_b16 v[40:41], v233 offset:24576
    ds_read_b64_tr_b16 v[42:43], v233 offset:26112
    v_mfma_f32_16x16x32_bf16 v[20:23], v[52:55], v[164:167], v[20:23]
    s_add_u32 m0, s55, 73728
    s_mov_b32 s51, 1376256
    buffer_load_dwordx4 v225, s[8:11], s51 offen lds
    s_waitcnt lgkmcnt(6)
    v_mfma_f32_16x16x32_bf16 v[24:27], v[56:59], v[160:163], v[24:27]
    ds_read_b64_tr_b16 v[44:45], v233 offset:24704
    ds_read_b64_tr_b16 v[46:47], v233 offset:26240
    v_mfma_f32_16x16x32_bf16 v[28:31], v[56:59], v[164:167], v[28:31]
    s_add_u32 m0, s55, 74752
    s_mov_b32 s51, 1376256
    buffer_load_dwordx4 v226, s[8:11], s51 offen lds
    s_waitcnt lgkmcnt(6)
    v_mfma_f32_16x16x32_bf16 v[32:35], v[160:163], v[60:63], v[32:35]
    ds_read_b64_tr_b16 v[48:49], v233 offset:24832
    ds_read_b64_tr_b16 v[50:51], v233 offset:26368
    v_mfma_f32_16x16x32_bf16 v[36:39], v[164:167], v[60:63], v[36:39]
    s_add_u32 m0, s55, 75776
    s_mov_b32 s51, 1376256
    buffer_load_dwordx4 v227, s[8:11], s51 offen lds
    s_waitcnt lgkmcnt(4)
    v_mfma_f32_16x16x32_bf16 v[16:19], v[40:43], v[168:171], v[16:19]
    ds_read_b128 v[176:179], v232 offset:40960
    ds_read_b128 v[180:183], v232 offset:43008
    ds_read_b64_tr_b16 v[52:53], v233 offset:36864
    ds_read_b64_tr_b16 v[54:55], v233 offset:38400
    v_mfma_f32_16x16x32_bf16 v[20:23], v[40:43], v[172:175], v[20:23]
    s_waitcnt lgkmcnt(6)
    v_mfma_f32_16x16x32_bf16 v[24:27], v[44:47], v[168:171], v[24:27]
    ds_read_b64_tr_b16 v[56:57], v233 offset:36992
    ds_read_b64_tr_b16 v[58:59], v233 offset:38528
    v_mfma_f32_16x16x32_bf16 v[28:31], v[44:47], v[172:175], v[28:31]
    s_waitcnt lgkmcnt(6)
    v_mfma_f32_16x16x32_bf16 v[32:35], v[168:171], v[48:51], v[32:35]
    ds_read_b64_tr_b16 v[60:61], v233 offset:37120
    ds_read_b64_tr_b16 v[62:63], v233 offset:38656
    v_mfma_f32_16x16x32_bf16 v[36:39], v[172:175], v[48:51], v[36:39]
    s_waitcnt vmcnt(3)
    s_barrier
    s_waitcnt lgkmcnt(4)
    v_mfma_f32_16x16x32_bf16 v[16:19], v[52:55], v[176:179], v[16:19]
    ds_read_b128 v[184:187], v231 offset:49152
    ds_read_b128 v[188:191], v231 offset:51200
    ds_read_b64_tr_b16 v[40:41], v234 offset:0
    ds_read_b64_tr_b16 v[42:43], v234 offset:1536
    v_mfma_f32_16x16x32_bf16 v[20:23], v[52:55], v[180:183], v[20:23]
    s_add_u32 m0, s55, 0
    s_mov_b32 s51, 0
    buffer_load_dwordx4 v228, s[12:15], s51 offen lds
    s_waitcnt lgkmcnt(6)
    v_mfma_f32_16x16x32_bf16 v[24:27], v[56:59], v[176:179], v[24:27]
    ds_read_b64_tr_b16 v[44:45], v234 offset:128
    ds_read_b64_tr_b16 v[46:47], v234 offset:1664
    v_mfma_f32_16x16x32_bf16 v[28:31], v[56:59], v[180:183], v[28:31]
    s_add_u32 m0, s55, 1024
    s_mov_b32 s51, 0
    buffer_load_dwordx4 v229, s[12:15], s51 offen lds
    s_waitcnt lgkmcnt(6)
    v_mfma_f32_16x16x32_bf16 v[32:35], v[176:179], v[60:63], v[32:35]
    ds_read_b64_tr_b16 v[48:49], v234 offset:256
    ds_read_b64_tr_b16 v[50:51], v234 offset:1792
    v_mfma_f32_16x16x32_bf16 v[36:39], v[180:183], v[60:63], v[36:39]
    s_add_u32 m0, s55, 2048
    s_mov_b32 s51, 0
    buffer_load_dwordx4 v230, s[12:15], s51 offen lds
    s_waitcnt lgkmcnt(4)
    v_mfma_f32_16x16x32_bf16 v[16:19], v[40:43], v[184:187], v[16:19]
    ds_read_b128 v[192:195], v232 offset:49152
    ds_read_b128 v[196:199], v232 offset:51200
    ds_read_b64_tr_b16 v[52:53], v234 offset:12288
    ds_read_b64_tr_b16 v[54:55], v234 offset:13824
    v_mfma_f32_16x16x32_bf16 v[20:23], v[40:43], v[188:191], v[20:23]
    s_waitcnt lgkmcnt(6)
    v_mfma_f32_16x16x32_bf16 v[24:27], v[44:47], v[184:187], v[24:27]
    ds_read_b64_tr_b16 v[56:57], v234 offset:12416
    ds_read_b64_tr_b16 v[58:59], v234 offset:13952
    v_mfma_f32_16x16x32_bf16 v[28:31], v[44:47], v[188:191], v[28:31]
    s_waitcnt lgkmcnt(6)
    v_mfma_f32_16x16x32_bf16 v[32:35], v[184:187], v[48:51], v[32:35]
    ds_read_b64_tr_b16 v[60:61], v234 offset:12544
    ds_read_b64_tr_b16 v[62:63], v234 offset:14080
    v_mfma_f32_16x16x32_bf16 v[36:39], v[188:191], v[48:51], v[36:39]
    s_waitcnt vmcnt(3)
    s_barrier
    s_waitcnt lgkmcnt(4)
    v_mfma_f32_16x16x32_bf16 v[16:19], v[52:55], v[192:195], v[16:19]
    ds_read_b128 v[200:203], v231 offset:57344
    ds_read_b128 v[204:207], v231 offset:59392
    ds_read_b64_tr_b16 v[40:41], v234 offset:24576
    ds_read_b64_tr_b16 v[42:43], v234 offset:26112
    v_mfma_f32_16x16x32_bf16 v[20:23], v[52:55], v[196:199], v[20:23]
    s_add_u32 m0, s55, 24576
    s_mov_b32 s51, 176128
    buffer_load_dwordx4 v228, s[12:15], s51 offen lds
    s_waitcnt lgkmcnt(6)
    v_mfma_f32_16x16x32_bf16 v[24:27], v[56:59], v[192:195], v[24:27]
    ds_read_b64_tr_b16 v[44:45], v234 offset:24704
    ds_read_b64_tr_b16 v[46:47], v234 offset:26240
    v_mfma_f32_16x16x32_bf16 v[28:31], v[56:59], v[196:199], v[28:31]
    s_add_u32 m0, s55, 25600
    s_mov_b32 s51, 176128
    buffer_load_dwordx4 v229, s[12:15], s51 offen lds
    s_waitcnt lgkmcnt(6)
    v_mfma_f32_16x16x32_bf16 v[32:35], v[192:195], v[60:63], v[32:35]
    ds_read_b64_tr_b16 v[48:49], v234 offset:24832
    ds_read_b64_tr_b16 v[50:51], v234 offset:26368
    v_mfma_f32_16x16x32_bf16 v[36:39], v[196:199], v[60:63], v[36:39]
    s_add_u32 m0, s55, 26624
    s_mov_b32 s51, 176128
    buffer_load_dwordx4 v230, s[12:15], s51 offen lds
    s_waitcnt lgkmcnt(4)
    v_mfma_f32_16x16x32_bf16 v[16:19], v[40:43], v[200:203], v[16:19]
    ds_read_b128 v[208:211], v232 offset:57344
    ds_read_b128 v[212:215], v232 offset:59392
    ds_read_b64_tr_b16 v[52:53], v234 offset:36864
    ds_read_b64_tr_b16 v[54:55], v234 offset:38400
    v_mfma_f32_16x16x32_bf16 v[20:23], v[40:43], v[204:207], v[20:23]
    s_waitcnt lgkmcnt(6)
    v_mfma_f32_16x16x32_bf16 v[24:27], v[44:47], v[200:203], v[24:27]
    ds_read_b64_tr_b16 v[56:57], v234 offset:36992
    ds_read_b64_tr_b16 v[58:59], v234 offset:38528
    v_mfma_f32_16x16x32_bf16 v[28:31], v[44:47], v[204:207], v[28:31]
    s_waitcnt lgkmcnt(6)
    v_mfma_f32_16x16x32_bf16 v[32:35], v[200:203], v[48:51], v[32:35]
    ds_read_b64_tr_b16 v[60:61], v234 offset:37120
    ds_read_b64_tr_b16 v[62:63], v234 offset:38656
    v_mfma_f32_16x16x32_bf16 v[36:39], v[204:207], v[48:51], v[36:39]
    s_waitcnt vmcnt(3)
    s_barrier
    s_waitcnt lgkmcnt(4)
    v_mfma_f32_16x16x32_bf16 v[16:19], v[52:55], v[208:211], v[16:19]
    ds_read_b64_tr_b16 v[40:41], v235 offset:0
    ds_read_b64_tr_b16 v[42:43], v235 offset:1536
    v_mfma_f32_16x16x32_bf16 v[20:23], v[52:55], v[212:215], v[20:23]
    s_add_u32 m0, s55, 49152
    s_mov_b32 s51, 352256
    buffer_load_dwordx4 v228, s[12:15], s51 offen lds
    s_waitcnt lgkmcnt(4)
    v_mfma_f32_16x16x32_bf16 v[24:27], v[56:59], v[208:211], v[24:27]
    ds_read_b64_tr_b16 v[44:45], v237 offset:0
    ds_read_b64_tr_b16 v[46:47], v237 offset:1536
    v_mfma_f32_16x16x32_bf16 v[28:31], v[56:59], v[212:215], v[28:31]
    s_add_u32 m0, s55, 50176
    s_mov_b32 s51, 352256
    buffer_load_dwordx4 v229, s[12:15], s51 offen lds
    s_waitcnt lgkmcnt(4)
    v_mfma_f32_16x16x32_bf16 v[32:35], v[208:211], v[60:63], v[32:35]
    ds_read_b64_tr_b16 v[48:49], v239 offset:0
    ds_read_b64_tr_b16 v[50:51], v239 offset:1536
    v_mfma_f32_16x16x32_bf16 v[36:39], v[212:215], v[60:63], v[36:39]
    s_add_u32 m0, s55, 51200
    s_mov_b32 s51, 352256
    buffer_load_dwordx4 v230, s[12:15], s51 offen lds
    s_nop 7
    s_mov_b32 s85, 0x3eb8aa3b
    v_cvt_pk_bf16_f32 v68, v24, v25
    v_cvt_pk_bf16_f32 v69, v26, v27
    v_cvt_pk_bf16_f32 v70, v28, v29
    v_cvt_pk_bf16_f32 v71, v30, v31
    s_nop 1
    v_permlane16_swap_b32 v68, v70
    v_permlane16_swap_b32 v69, v71
    v_cvt_pk_bf16_f32 v72, v32, v33
    v_cvt_pk_bf16_f32 v73, v34, v35
    v_cvt_pk_bf16_f32 v74, v36, v37
    v_cvt_pk_bf16_f32 v75, v38, v39
    s_nop 1
    v_permlane32_swap_b32 v72, v74
    v_permlane32_swap_b32 v73, v75
    v_mul_f32 v16, s85, v16
    v_mul_f32 v17, s85, v17
    v_mul_f32 v18, s85, v18
    v_mul_f32 v19, s85, v19
    v_mul_f32 v20, s85, v20
    v_mul_f32 v21, s85, v21
    v_mul_f32 v22, s85, v22
    v_mul_f32 v23, s85, v23
    v_cvt_pk_bf16_f32 v64, v16, v17
    v_cvt_pk_bf16_f32 v65, v18, v19
    v_cvt_pk_bf16_f32 v66, v20, v21
    v_cvt_pk_bf16_f32 v67, v22, v23
    s_nop 1
    v_permlane16_swap_b32 v64, v66
    v_permlane16_swap_b32 v65, v67
    s_lshl_b32 s48, s44, 2
    s_add_u32 s48, s48, s56
    s_lshl_b32 s48, s48, 6
    s_lshl_b32 s49, s45, 1
    s_add_u32 s48, s48, s49
    s_add_u32 s48, s48, s57
    s_lshl_b32 s89, s48, 2
    s_add_u32 s89, s89, 4096
    s_lshl_b32 s48, s48, 10
    s_add_u32 s49, s48, 3145728
    s_add_u32 s48, s48, 1048576
    buffer_store_dwordx4 v[68:71], v2, s[28:31], s48 offen sc1
    buffer_store_dwordx4 v[72:75], v2, s[28:31], s49 offen sc1
    s_waitcnt lgkmcnt(4)
    v_mfma_f32_16x16x32_bf16 v[16:19], v[40:43], v[88:91], 0
    ds_read_b64_tr_b16 v[52:53], v235 offset:12288
    ds_read_b64_tr_b16 v[54:55], v235 offset:13824
    v_mfma_f32_16x16x32_bf16 v[20:23], v[40:43], v[92:95], 0
    s_waitcnt lgkmcnt(4)
    v_mfma_f32_16x16x32_bf16 v[24:27], v[44:47], v[88:91], 0
    ds_read_b64_tr_b16 v[56:57], v237 offset:12288
    ds_read_b64_tr_b16 v[58:59], v237 offset:13824
    v_mfma_f32_16x16x32_bf16 v[28:31], v[44:47], v[92:95], 0
    s_waitcnt lgkmcnt(4)
    v_mfma_f32_16x16x32_bf16 v[32:35], v[48:51], v[88:91], 0
    ds_read_b64_tr_b16 v[60:61], v239 offset:12288
    ds_read_b64_tr_b16 v[62:63], v239 offset:13824
    v_mfma_f32_16x16x32_bf16 v[36:39], v[48:51], v[92:95], 0
    s_waitcnt vmcnt(5)
    s_barrier
    s_lshl_b32 s48, s44, 3
    s_add_u32 s48, s48, s46
    s_lshr_b32 s49, s48, 1
    s_and_b32 s49, s49, 7
    s_lshl_b32 s50, s48, 7
    s_add_u32 s50, s50, 98304
    v_and_b32 v84, 7, v1
    v_xor_b32 v84, s49, v84
    v_lshlrev_b32 v84, 4, v84
    v_lshrrev_b32 v85, 3, v1
    v_lshl_add_u32 v84, v85, 13, v84
    v_add_u32 v84, s50, v84
    ds_read_b128 v[80:83], v84
    s_lshl_b32 s49, s45, 6
    s_add_u32 s48, s48, s49
    s_lshl_b32 s48, s48, 2
    s_add_u32 s90, s48, 32768
    s_waitcnt lgkmcnt(5)
    v_mfma_f32_16x16x32_bf16 v[16:19], v[52:55], v[96:99], v[16:19]
    ds_read_b64_tr_b16 v[40:41], v235 offset:24576
    ds_read_b64_tr_b16 v[42:43], v235 offset:26112
    v_mfma_f32_16x16x32_bf16 v[20:23], v[52:55], v[100:103], v[20:23]
    s_add_u32 m0, s55, 73728
    s_mov_b32 s51, 528384
    buffer_load_dwordx4 v228, s[12:15], s51 offen lds
    s_waitcnt lgkmcnt(5)
    v_mfma_f32_16x16x32_bf16 v[24:27], v[56:59], v[96:99], v[24:27]
    ds_read_b64_tr_b16 v[44:45], v237 offset:24576
    ds_read_b64_tr_b16 v[46:47], v237 offset:26112
    v_mfma_f32_16x16x32_bf16 v[28:31], v[56:59], v[100:103], v[28:31]
    s_add_u32 m0, s55, 74752
    s_mov_b32 s51, 528384
    buffer_load_dwordx4 v229, s[12:15], s51 offen lds
    s_waitcnt lgkmcnt(5)
    v_mfma_f32_16x16x32_bf16 v[32:35], v[60:63], v[96:99], v[32:35]
    ds_read_b64_tr_b16 v[48:49], v239 offset:24576
    ds_read_b64_tr_b16 v[50:51], v239 offset:26112
    v_mfma_f32_16x16x32_bf16 v[36:39], v[60:63], v[100:103], v[36:39]
    s_add_u32 m0, s55, 75776
    s_mov_b32 s51, 528384
    buffer_load_dwordx4 v230, s[12:15], s51 offen lds
    s_waitcnt lgkmcnt(4)
    v_mfma_f32_16x16x32_bf16 v[16:19], v[40:43], v[104:107], v[16:19]
    ds_read_b64_tr_b16 v[52:53], v235 offset:36864
    ds_read_b64_tr_b16 v[54:55], v235 offset:38400
    v_mfma_f32_16x16x32_bf16 v[20:23], v[40:43], v[108:111], v[20:23]
    s_waitcnt lgkmcnt(4)
    v_mfma_f32_16x16x32_bf16 v[24:27], v[44:47], v[104:107], v[24:27]
    ds_read_b64_tr_b16 v[56:57], v237 offset:36864
    ds_read_b64_tr_b16 v[58:59], v237 offset:38400
    v_mfma_f32_16x16x32_bf16 v[28:31], v[44:47], v[108:111], v[28:31]
    s_waitcnt lgkmcnt(4)
    v_mfma_f32_16x16x32_bf16 v[32:35], v[48:51], v[104:107], v[32:35]
    ds_read_b64_tr_b16 v[60:61], v239 offset:36864
    ds_read_b64_tr_b16 v[62:63], v239 offset:38400
    v_mfma_f32_16x16x32_bf16 v[36:39], v[48:51], v[108:111], v[36:39]
    s_waitcnt vmcnt(5)
    s_barrier
    s_lshl_b32 s48, s46, 10
    s_add_u32 s48, s48, 155648
    v_add_u32 v5, s48, v2
    ds_write_b128 v5, v[64:67]
    s_waitcnt lgkmcnt(5)
    v_mfma_f32_16x16x32_bf16 v[16:19], v[52:55], v[112:115], v[16:19]
    v_mov_b32 v86, 0
    v_lshlrev_b32 v84, 16, v80
    ds_read_b64_tr_b16 v[40:41], v236 offset:0
    ds_read_b64_tr_b16 v[42:43], v236 offset:1536
    v_mfma_f32_16x16x32_bf16 v[20:23], v[52:55], v[116:119], v[20:23]
    v_lshlrev_b32 v85, 16, v76
    v_and_b32 v80, 0xffff0000, v80
    s_add_u32 m0, s55, 0
    s_mov_b32 s51, 704512
    buffer_load_dwordx4 v228, s[12:15], s51 offen lds
    s_waitcnt lgkmcnt(5)
    v_mfma_f32_16x16x32_bf16 v[24:27], v[56:59], v[112:115], v[24:27]
    v_and_b32 v76, 0xffff0000, v76
    v_mul_f32 v84, v84, v85
    ds_read_b64_tr_b16 v[44:45], v238 offset:0
    ds_read_b64_tr_b16 v[46:47], v238 offset:1536
    v_mfma_f32_16x16x32_bf16 v[28:31], v[56:59], v[116:119], v[28:31]
    v_mul_f32 v85, v80, v76
    v_cvt_pk_bf16_f32 v84, v84, v85
    s_add_u32 m0, s55, 1024
    s_mov_b32 s51, 704512
    buffer_load_dwordx4 v229, s[12:15], s51 offen lds
    s_waitcnt lgkmcnt(5)
    v_mfma_f32_16x16x32_bf16 v[32:35], v[60:63], v[112:115], v[32:35]
    v_lshlrev_b32 v85, 16, v84
    v_and_b32 v84, 0xffff0000, v84
    ds_read_b64_tr_b16 v[48:49], v240 offset:0
    ds_read_b64_tr_b16 v[50:51], v240 offset:1536
    v_mfma_f32_16x16x32_bf16 v[36:39], v[60:63], v[116:119], v[36:39]
    v_add_f32 v86, v86, v85
    v_add_f32 v86, v86, v84
    s_add_u32 m0, s55, 2048
    s_mov_b32 s51, 704512
    buffer_load_dwordx4 v230, s[12:15], s51 offen lds
    s_waitcnt lgkmcnt(4)
    v_mfma_f32_16x16x32_bf16 v[16:19], v[40:43], v[120:123], v[16:19]
    v_lshlrev_b32 v84, 16, v81
    v_lshlrev_b32 v85, 16, v77
    ds_read_b64_tr_b16 v[52:53], v236 offset:12288
    ds_read_b64_tr_b16 v[54:55], v236 offset:13824
    v_mfma_f32_16x16x32_bf16 v[20:23], v[40:43], v[124:127], v[20:23]
    v_and_b32 v81, 0xffff0000, v81
    v_and_b32 v77, 0xffff0000, v77
    s_waitcnt lgkmcnt(4)
    v_mfma_f32_16x16x32_bf16 v[24:27], v[44:47], v[120:123], v[24:27]
    v_mul_f32 v84, v84, v85
    v_mul_f32 v85, v81, v77
    ds_read_b64_tr_b16 v[56:57], v238 offset:12288
    ds_read_b64_tr_b16 v[58:59], v238 offset:13824
    v_mfma_f32_16x16x32_bf16 v[28:31], v[44:47], v[124:127], v[28:31]
    v_cvt_pk_bf16_f32 v84, v84, v85
    v_lshlrev_b32 v85, 16, v84
    s_waitcnt lgkmcnt(4)
    v_mfma_f32_16x16x32_bf16 v[32:35], v[48:51], v[120:123], v[32:35]
    v_and_b32 v84, 0xffff0000, v84
    v_add_f32 v86, v86, v85
    ds_read_b64_tr_b16 v[60:61], v240 offset:12288
    ds_read_b64_tr_b16 v[62:63], v240 offset:13824
    v_mfma_f32_16x16x32_bf16 v[36:39], v[48:51], v[124:127], v[36:39]
    v_add_f32 v86, v86, v84
    v_lshlrev_b32 v84, 16, v82
    s_waitcnt vmcnt(3)
    s_barrier
    v_mov_b32 v3, s47
    v_mov_b32 v4, 0
    s_mov_b64 exec, 1
    buffer_store_dword v3, v4, s[28:31], s89 offen sc1
    s_mov_b64 exec, -1
    s_waitcnt lgkmcnt(4)
    v_mfma_f32_16x16x32_bf16 v[16:19], v[52:55], v[128:131], v[16:19]
    v_lshlrev_b32 v85, 16, v78
    v_and_b32 v82, 0xffff0000, v82
    ds_read_b64_tr_b16 v[40:41], v236 offset:24576
    ds_read_b64_tr_b16 v[42:43], v236 offset:26112
    v_mfma_f32_16x16x32_bf16 v[20:23], v[52:55], v[132:135], v[20:23]
    v_and_b32 v78, 0xffff0000, v78
    v_mul_f32 v84, v84, v85
    s_add_u32 m0, s55, 24576
    s_mov_b32 s51, 880640
    buffer_load_dwordx4 v228, s[12:15], s51 offen lds
    s_waitcnt lgkmcnt(4)
    v_mfma_f32_16x16x32_bf16 v[24:27], v[56:59], v[128:131], v[24:27]
    v_mul_f32 v85, v82, v78
    v_cvt_pk_bf16_f32 v84, v84, v85
    ds_read_b64_tr_b16 v[44:45], v238 offset:24576
    ds_read_b64_tr_b16 v[46:47], v238 offset:26112
    v_mfma_f32_16x16x32_bf16 v[28:31], v[56:59], v[132:135], v[28:31]
    v_lshlrev_b32 v85, 16, v84
    v_and_b32 v84, 0xffff0000, v84
    s_add_u32 m0, s55, 25600
    s_mov_b32 s51, 880640
    buffer_load_dwordx4 v229, s[12:15], s51 offen lds
    s_waitcnt lgkmcnt(4)
    v_mfma_f32_16x16x32_bf16 v[32:35], v[60:63], v[128:131], v[32:35]
    v_add_f32 v86, v86, v85
    v_add_f32 v86, v86, v84
    ds_read_b64_tr_b16 v[48:49], v240 offset:24576
    ds_read_b64_tr_b16 v[50:51], v240 offset:26112
    v_mfma_f32_16x16x32_bf16 v[36:39], v[60:63], v[132:135], v[36:39]
    v_lshlrev_b32 v84, 16, v83
    v_lshlrev_b32 v85, 16, v79
    s_add_u32 m0, s55, 26624
    s_mov_b32 s51, 880640
    buffer_load_dwordx4 v230, s[12:15], s51 offen lds
    s_waitcnt lgkmcnt(4)
    v_mfma_f32_16x16x32_bf16 v[16:19], v[40:43], v[136:139], v[16:19]
    v_and_b32 v83, 0xffff0000, v83
    v_and_b32 v79, 0xffff0000, v79
    ds_read_b64_tr_b16 v[52:53], v236 offset:36864
    ds_read_b64_tr_b16 v[54:55], v236 offset:38400
    v_mfma_f32_16x16x32_bf16 v[20:23], v[40:43], v[140:143], v[20:23]
    v_mul_f32 v84, v84, v85
    v_mul_f32 v85, v83, v79
    s_waitcnt lgkmcnt(4)
    v_mfma_f32_16x16x32_bf16 v[24:27], v[44:47], v[136:139], v[24:27]
    v_cvt_pk_bf16_f32 v84, v84, v85
    v_lshlrev_b32 v85, 16, v84
    ds_read_b64_tr_b16 v[56:57], v238 offset:36864
    ds_read_b64_tr_b16 v[58:59], v238 offset:38400
    v_mfma_f32_16x16x32_bf16 v[28:31], v[44:47], v[140:143], v[28:31]
    v_and_b32 v84, 0xffff0000, v84
    v_add_f32 v86, v86, v85
    s_waitcnt lgkmcnt(4)
    v_mfma_f32_16x16x32_bf16 v[32:35], v[48:51], v[136:139], v[32:35]
    v_add_f32 v86, v86, v84
    s_nop 1
    ds_read_b64_tr_b16 v[60:61], v240 offset:36864
    ds_read_b64_tr_b16 v[62:63], v240 offset:38400
    v_mfma_f32_16x16x32_bf16 v[36:39], v[48:51], v[140:143], v[36:39]
    v_add_f32_dpp v86, v86, v86 row_shr:1 bound_ctrl:0
    s_nop 1
    s_waitcnt vmcnt(4)
    s_barrier
    s_lshl_b32 s48, s44, 2
    s_add_u32 s48, s48, s56
    s_lshl_b32 s49, s48, 1
    s_add_u32 s49, s49, s57
    s_lshl_b32 s50, s49, 15
    s_add_u32 s50, s50, 1048576
    s_add_u32 s36, s82, s50
    s_addc_u32 s37, s83, 0
    s_mov_b32 s38, 0x8000
    s_mov_b32 s39, 0x20000
    s_add_u32 s40, s36, 2097152
    s_addc_u32 s41, s37, 0
    s_mov_b32 s42, 0x8000
    s_mov_b32 s43, 0x20000
    s_lshl_b32 s58, s88, 11
    s_lshl_b32 s49, s49, 7
    s_add_u32 s49, s49, 4096
    s_mov_b32 s3, s49
    s_waitcnt lgkmcnt(4)
    v_mfma_f32_16x16x32_bf16 v[16:19], v[52:55], v[144:147], v[16:19]
    v_add_f32_dpp v86, v86, v86 row_shr:2 bound_ctrl:0
    s_nop 1
    ds_read_b64_tr_b16 v[40:41], v235 offset:0
    ds_read_b64_tr_b16 v[42:43], v235 offset:1536
    v_mfma_f32_16x16x32_bf16 v[20:23], v[52:55], v[148:151], v[20:23]
    v_add_f32_dpp v86, v86, v86 row_shr:4 bound_ctrl:0
    s_nop 1
    s_add_u32 m0, s55, 49152
    s_mov_b32 s51, 1056768
    buffer_load_dwordx4 v228, s[12:15], s51 offen lds
    s_waitcnt lgkmcnt(4)
    v_mfma_f32_16x16x32_bf16 v[24:27], v[56:59], v[144:147], v[24:27]
    v_add_f32_dpp v86, v86, v86 row_shr:8 bound_ctrl:0
    s_nop 1
    ds_read_b64_tr_b16 v[44:45], v237 offset:0
    ds_read_b64_tr_b16 v[46:47], v237 offset:1536
    v_mfma_f32_16x16x32_bf16 v[28:31], v[56:59], v[148:151], v[28:31]
    v_add_f32_dpp v86, v86, v86 row_bcast:15 row_mask:0xa
    s_nop 1
    s_add_u32 m0, s55, 50176
    s_mov_b32 s51, 1056768
    buffer_load_dwordx4 v229, s[12:15], s51 offen lds
    s_waitcnt lgkmcnt(4)
    v_mfma_f32_16x16x32_bf16 v[32:35], v[60:63], v[144:147], v[32:35]
    v_add_f32_dpp v86, v86, v86 row_bcast:31 row_mask:0xc
    s_nop 1
    ds_read_b64_tr_b16 v[48:49], v239 offset:0
    ds_read_b64_tr_b16 v[50:51], v239 offset:1536
    v_mfma_f32_16x16x32_bf16 v[36:39], v[60:63], v[148:151], v[36:39]
    v_readlane_b32 s91, v86, 63
    s_nop 1
    s_add_u32 m0, s55, 51200
    s_mov_b32 s51, 1056768
    buffer_load_dwordx4 v230, s[12:15], s51 offen lds
    s_waitcnt lgkmcnt(4)
    v_mfma_f32_16x16x32_bf16 v[16:19], v[40:43], v[152:155], v[16:19]
    v_mov_b32 v84, s91
    v_cvt_pk_bf16_f32 v84, v84, v84
    ds_read_b64_tr_b16 v[52:53], v235 offset:12288
    ds_read_b64_tr_b16 v[54:55], v235 offset:13824
    v_mfma_f32_16x16x32_bf16 v[20:23], v[40:43], v[156:159], v[20:23]
    v_lshlrev_b32 v84, 16, v84
    v_mul_f32 v84, 0xbfb8aa3b, v84
    s_waitcnt lgkmcnt(4)
    v_mfma_f32_16x16x32_bf16 v[24:27], v[44:47], v[152:155], v[24:27]
    v_exp_f32 v84, v84
    s_nop 0
    ds_read_b64_tr_b16 v[56:57], v237 offset:12288
    ds_read_b64_tr_b16 v[58:59], v237 offset:13824
    v_mfma_f32_16x16x32_bf16 v[28:31], v[44:47], v[156:159], v[28:31]
    v_add_f32 v84, 1.0, v84
    v_rcp_f32 v84, v84
    s_waitcnt lgkmcnt(4)
    v_mfma_f32_16x16x32_bf16 v[32:35], v[48:51], v[152:155], v[32:35]
    s_nop 0
    v_cvt_pk_bf16_f32 v84, v84, v84
    ds_read_b64_tr_b16 v[60:61], v239 offset:12288
    ds_read_b64_tr_b16 v[62:63], v239 offset:13824
    v_mfma_f32_16x16x32_bf16 v[36:39], v[48:51], v[156:159], v[36:39]
    v_lshlrev_b32 v84, 16, v84
    v_mov_b32 v85, 0
    s_waitcnt vmcnt(3)
    s_barrier
    s_mov_b32 exec_lo, -1
    s_mov_b32 exec_hi, 0
    buffer_load_dword v251, v252, s[28:31], s3 offen sc1
    s_mov_b64 exec, -1
    s_waitcnt lgkmcnt(4)
    v_mfma_f32_16x16x32_bf16 v[16:19], v[52:55], v[160:163], v[16:19]
    s_mov_b64 exec, 1
    buffer_store_dword v84, v85, s[28:31], s90 offen sc1
    s_mov_b64 exec, -1
    v_and_b32 v87, 27, v1
    ds_read_b64_tr_b16 v[40:41], v235 offset:24576
    ds_read_b64_tr_b16 v[42:43], v235 offset:26112
    v_mfma_f32_16x16x32_bf16 v[20:23], v[52:55], v[164:167], v[20:23]
    v_cmp_eq_u32 vcc, 16, v87
    v_mov_b32 v75, 0x3f803f80
    s_add_u32 m0, s55, 73728
    s_mov_b32 s51, 1232896
    buffer_load_dwordx4 v228, s[12:15], s51 offen lds
    s_waitcnt lgkmcnt(4)
    v_mfma_f32_16x16x32_bf16 v[24:27], v[56:59], v[160:163], v[24:27]
    s_nop 0
    v_cndmask_b32 v87, 0, v75, vcc
    ds_read_b64_tr_b16 v[44:45], v237 offset:24576
    ds_read_b64_tr_b16 v[46:47], v237 offset:26112
    v_mfma_f32_16x16x32_bf16 v[28:31], v[56:59], v[164:167], v[28:31]
    v_mov_b32 v104, v87
    v_mov_b32 v105, v87
    s_add_u32 m0, s55, 74752
    s_mov_b32 s51, 1232896
    buffer_load_dwordx4 v229, s[12:15], s51 offen lds
    s_waitcnt lgkmcnt(4)
    v_mfma_f32_16x16x32_bf16 v[32:35], v[60:63], v[160:163], v[32:35]
    v_mov_b32 v106, v87
    v_mov_b32 v107, v87
    ds_read_b64_tr_b16 v[48:49], v239 offset:24576
    ds_read_b64_tr_b16 v[50:51], v239 offset:26112
    v_mfma_f32_16x16x32_bf16 v[36:39], v[60:63], v[164:167], v[36:39]
    v_mov_b32 v108, v87
    v_mov_b32 v109, v87
    s_add_u32 m0, s55, 75776
    s_mov_b32 s51, 1232896
    buffer_load_dwordx4 v230, s[12:15], s51 offen lds
    s_waitcnt lgkmcnt(4)
    v_mfma_f32_16x16x32_bf16 v[16:19], v[40:43], v[168:171], v[16:19]
    v_mov_b32 v110, v87
    v_mov_b32 v111, v87
    ds_read_b64_tr_b16 v[52:53], v235 offset:36864
    ds_read_b64_tr_b16 v[54:55], v235 offset:38400
    v_mfma_f32_16x16x32_bf16 v[20:23], v[40:43], v[172:175], v[20:23]
    v_mov_b32 v112, v87
    v_mov_b32 v113, v87
    s_waitcnt lgkmcnt(4)
    v_mfma_f32_16x16x32_bf16 v[24:27], v[44:47], v[168:171], v[24:27]
    v_mov_b32 v114, v87
    v_mov_b32 v115, v87
    ds_read_b64_tr_b16 v[56:57], v237 offset:36864
    ds_read_b64_tr_b16 v[58:59], v237 offset:38400
    v_mfma_f32_16x16x32_bf16 v[28:31], v[44:47], v[172:175], v[28:31]
    v_mov_b32 v116, v87
    v_mov_b32 v117, v87
    s_waitcnt lgkmcnt(4)
    v_mfma_f32_16x16x32_bf16 v[32:35], v[48:51], v[168:171], v[32:35]
    v_mov_b32 v118, v87
    v_mov_b32 v119, v87
    ds_read_b64_tr_b16 v[60:61], v239 offset:36864
    ds_read_b64_tr_b16 v[62:63], v239 offset:38400
    v_mfma_f32_16x16x32_bf16 v[36:39], v[48:51], v[172:175], v[36:39]
    v_mov_b32 v120, v87
    v_mov_b32 v121, v87
    s_waitcnt vmcnt(5)
    s_barrier
    s_lshl_b32 s48, s56, 11
    s_add_u32 s48, s48, 155648
    v_add_u32 v5, s48, v2
    ds_read_b128 v[8:11], v5
    ds_read_b128 v[12:15], v5 offset:1024
    s_waitcnt lgkmcnt(6)
    v_mfma_f32_16x16x32_bf16 v[16:19], v[52:55], v[176:179], v[16:19]
    v_mov_b32 v122, v87
    v_mov_b32 v123, v87
    ds_read_b64_tr_b16 v[40:41], v236 offset:0
    ds_read_b64_tr_b16 v[42:43], v236 offset:1536
    v_mfma_f32_16x16x32_bf16 v[20:23], v[52:55], v[180:183], v[20:23]
    v_mov_b32 v124, v87
    v_mov_b32 v125, v87
    s_waitcnt lgkmcnt(6)
    v_mfma_f32_16x16x32_bf16 v[24:27], v[56:59], v[176:179], v[24:27]
    v_mov_b32 v126, v87
    v_mov_b32 v127, v87
    ds_read_b64_tr_b16 v[44:45], v238 offset:0
    ds_read_b64_tr_b16 v[46:47], v238 offset:1536
    v_mfma_f32_16x16x32_bf16 v[28:31], v[56:59], v[180:183], v[28:31]
    v_mov_b32 v128, v87
    v_mov_b32 v129, v87
    s_waitcnt lgkmcnt(6)
    v_mfma_f32_16x16x32_bf16 v[32:35], v[60:63], v[176:179], v[32:35]
    v_mov_b32 v130, v87
    v_mov_b32 v131, v87
    ds_read_b64_tr_b16 v[48:49], v240 offset:0
    ds_read_b64_tr_b16 v[50:51], v240 offset:1536
    v_mfma_f32_16x16x32_bf16 v[36:39], v[60:63], v[180:183], v[36:39]
    v_mov_b32 v132, v87
    v_mov_b32 v133, v87
    s_waitcnt lgkmcnt(4)
    v_mfma_f32_16x16x32_bf16 v[16:19], v[40:43], v[184:187], v[16:19]
    v_mov_b32 v134, v87
    v_mov_b32 v135, v87
    ds_read_b64_tr_b16 v[52:53], v236 offset:12288
    ds_read_b64_tr_b16 v[54:55], v236 offset:13824
    v_mfma_f32_16x16x32_bf16 v[20:23], v[40:43], v[188:191], v[20:23]
    s_waitcnt lgkmcnt(4)
    v_mfma_f32_16x16x32_bf16 v[24:27], v[44:47], v[184:187], v[24:27]
    ds_read_b64_tr_b16 v[56:57], v238 offset:12288
    ds_read_b64_tr_b16 v[58:59], v238 offset:13824
    v_mfma_f32_16x16x32_bf16 v[28:31], v[44:47], v[188:191], v[28:31]
    s_waitcnt lgkmcnt(4)
    v_mfma_f32_16x16x32_bf16 v[32:35], v[48:51], v[184:187], v[32:35]
    ds_read_b64_tr_b16 v[60:61], v240 offset:12288
    ds_read_b64_tr_b16 v[62:63], v240 offset:13824
    v_mfma_f32_16x16x32_bf16 v[36:39], v[48:51], v[188:191], v[36:39]
    s_waitcnt vmcnt(0)
    s_barrier
    v_mov_b32 v3, 163584
    v_mov_b32 v4, 0
    ds_write_b32 v3, v4
    s_mov_b32 exec_lo, -1
    s_mov_b32 exec_hi, 0
    v_cmp_ne_u32 vcc, s47, v251
    s_cbranch_vccz L_polled_a
    s_mov_b32 s84, 0
L_poll_a:
    s_sleep 1
    buffer_load_dword v251, v252, s[28:31], s3 offen sc1
    s_add_u32 s84, s84, 1
    s_waitcnt vmcnt(0)
    v_cmp_ne_u32 vcc, s47, v251
    s_cmp_ge_u32 s84, 400000
    s_cbranch_scc1 L_polled_a
    s_cbranch_vccnz L_poll_a
L_polled_a:
    s_mov_b64 exec, -1
    s_waitcnt lgkmcnt(5)
    v_mfma_f32_16x16x32_bf16 v[16:19], v[52:55], v[192:195], v[16:19]
    ds_read_b64_tr_b16 v[40:41], v236 offset:24576
    ds_read_b64_tr_b16 v[42:43], v236 offset:26112
    v_mfma_f32_16x16x32_bf16 v[20:23], v[52:55], v[196:199], v[20:23]
    s_waitcnt lgkmcnt(5)
    v_mfma_f32_16x16x32_bf16 v[24:27], v[56:59], v[192:195], v[24:27]
    ds_read_b64_tr_b16 v[44:45], v238 offset:24576
    ds_read_b64_tr_b16 v[46:47], v238 offset:26112
    v_mfma_f32_16x16x32_bf16 v[28:31], v[56:59], v[196:199], v[28:31]
    s_waitcnt lgkmcnt(5)
    v_mfma_f32_16x16x32_bf16 v[32:35], v[60:63], v[192:195], v[32:35]
    ds_read_b64_tr_b16 v[48:49], v240 offset:24576
    ds_read_b64_tr_b16 v[50:51], v240 offset:26112
    v_mfma_f32_16x16x32_bf16 v[36:39], v[60:63], v[196:199], v[36:39]
    s_xor_b32 s59, s58, 0
    buffer_load_dwordx4 v[88:91], v2, s[36:39], s59 offen sc1
    s_mov_b64 exec, s[52:53]
    buffer_load_dwordx4 v[104:107], v6, s[40:43], s59 offen sc1
    buffer_load_dwordx4 v[108:111], v6, s[40:43], s59 offen offset:512 sc1
    s_mov_b64 exec, -1
    s_waitcnt lgkmcnt(4)
    v_mfma_f32_16x16x32_bf16 v[16:19], v[40:43], v[200:203], v[16:19]
    ds_read_b64_tr_b16 v[52:53], v236 offset:36864
    ds_read_b64_tr_b16 v[54:55], v236 offset:38400
    v_mfma_f32_16x16x32_bf16 v[20:23], v[40:43], v[204:207], v[20:23]
    s_waitcnt lgkmcnt(4)
    v_mfma_f32_16x16x32_bf16 v[24:27], v[44:47], v[200:203], v[24:27]
    ds_read_b64_tr_b16 v[56:57], v238 offset:36864
    ds_read_b64_tr_b16 v[58:59], v238 offset:38400
    v_mfma_f32_16x16x32_bf16 v[28:31], v[44:47], v[204:207], v[28:31]
    s_waitcnt lgkmcnt(4)
    v_mfma_f32_16x16x32_bf16 v[32:35], v[48:51], v[200:203], v[32:35]
    ds_read_b64_tr_b16 v[60:61], v240 offset:36864
    ds_read_b64_tr_b16 v[62:63], v240 offset:38400
    v_mfma_f32_16x16x32_bf16 v[36:39], v[48:51], v[204:207], v[36:39]
    s_xor_b32 s59, s58, 1024
    buffer_load_dwordx4 v[92:95], v2, s[36:39], s59 offen sc1
    s_mov_b64 exec, s[52:53]
    buffer_load_dwordx4 v[112:115], v6, s[40:43], s59 offen sc1
    buffer_load_dwordx4 v[116:119], v6, s[40:43], s59 offen offset:512 sc1
    s_mov_b64 exec, -1
    s_waitcnt lgkmcnt(4)
    v_mfma_f32_16x16x32_bf16 v[16:19], v[52:55], v[208:211], v[16:19]
    v_mfma_f32_16x16x32_bf16 v[20:23], v[52:55], v[212:215], v[20:23]
    s_waitcnt lgkmcnt(2)
    v_mfma_f32_16x16x32_bf16 v[24:27], v[56:59], v[208:211], v[24:27]
    v_mfma_f32_16x16x32_bf16 v[28:31], v[56:59], v[212:215], v[28:31]
    s_waitcnt lgkmcnt(0)
    v_mfma_f32_16x16x32_bf16 v[32:35], v[60:63], v[208:211], v[32:35]
    v_mfma_f32_16x16x32_bf16 v[36:39], v[60:63], v[212:215], v[36:39]
    s_xor_b32 s59, s58, 2048
    buffer_load_dwordx4 v[96:99], v2, s[36:39], s59 offen sc1
    s_mov_b64 exec, s[52:53]
    buffer_load_dwordx4 v[120:123], v6, s[40:43], s59 offen sc1
    buffer_load_dwordx4 v[124:127], v6, s[40:43], s59 offen offset:512 sc1
    s_mov_b64 exec, -1
    s_xor_b32 s59, s58, 3072
    s_setprio 2
    s_cmp_ge_u32 s46, 4
    s_cbranch_scc0 L_prio_s
    s_setprio 3
L_prio_s:
    s_mov_b32 s86, 0xbfb8aa3b
    s_mov_b32 s87, 0xbfb8aa3b
    s_mov_b32 s84, 1.0
    s_mov_b32 s85, 1.0
    s_nop 7
    v_pk_mul_f32 v[40:41], v[16:17], s[86:87]
    v_pk_mul_f32 v[42:43], v[18:19], s[86:87]
    v_pk_mul_f32 v[44:45], v[20:21], s[86:87]
    v_pk_mul_f32 v[46:47], v[22:23], s[86:87]
    v_exp_f32 v40, v40
    v_exp_f32 v41, v41
    v_exp_f32 v42, v42
    v_exp_f32 v43, v43
    v_exp_f32 v44, v44
    v_exp_f32 v45, v45
    v_exp_f32 v46, v46
    v_exp_f32 v47, v47
    v_pk_add_f32 v[40:41], v[40:41], s[84:85]
    v_pk_add_f32 v[42:43], v[42:43], s[84:85]
    v_pk_add_f32 v[44:45], v[44:45], s[84:85]
    v_pk_add_f32 v[46:47], v[46:47], s[84:85]
    v_rcp_f32 v40, v40
    v_rcp_f32 v41, v41
    v_rcp_f32 v42, v42
    v_rcp_f32 v43, v43
    v_rcp_f32 v44, v44
    v_rcp_f32 v45, v45
    v_rcp_f32 v46, v46
    v_rcp_f32 v47, v47
    v_pk_mul_f32 v[16:17], v[16:17], v[40:41]
    v_pk_mul_f32 v[18:19], v[18:19], v[42:43]
    v_pk_mul_f32 v[20:21], v[20:21], v[44:45]
    v_pk_mul_f32 v[22:23], v[22:23], v[46:47]
    v_cvt_pk_bf16_f32 v52, v16, v17
    v_cvt_pk_bf16_f32 v53, v18, v19
    v_cvt_pk_bf16_f32 v54, v20, v21
    v_cvt_pk_bf16_f32 v55, v22, v23
    s_nop 1
    v_permlane16_swap_b32 v52, v54
    v_permlane16_swap_b32 v53, v55
    v_pk_mul_f32 v[40:41], v[24:25], s[86:87]
    v_pk_mul_f32 v[42:43], v[26:27], s[86:87]
    v_pk_mul_f32 v[44:45], v[28:29], s[86:87]
    v_pk_mul_f32 v[46:47], v[30:31], s[86:87]
    v_exp_f32 v40, v40
    v_exp_f32 v41, v41
    v_exp_f32 v42, v42
    v_exp_f32 v43, v43
    v_exp_f32 v44, v44
    v_exp_f32 v45, v45
    v_exp_f32 v46, v46
    v_exp_f32 v47, v47
    v_pk_add_f32 v[40:41], v[40:41], s[84:85]
    v_pk_add_f32 v[42:43], v[42:43], s[84:85]
    v_pk_add_f32 v[44:45], v[44:45], s[84:85]
    v_pk_add_f32 v[46:47], v[46:47], s[84:85]
    v_rcp_f32 v40, v40
    v_rcp_f32 v41, v41
    v_rcp_f32 v42, v42
    v_rcp_f32 v43, v43
    v_rcp_f32 v44, v44
    v_rcp_f32 v45, v45
    v_rcp_f32 v46, v46
    v_rcp_f32 v47, v47
    v_pk_mul_f32 v[24:25], v[24:25], v[40:41]
    v_pk_mul_f32 v[26:27], v[26:27], v[42:43]
    v_pk_mul_f32 v[28:29], v[28:29], v[44:45]
    v_pk_mul_f32 v[30:31], v[30:31], v[46:47]
    v_cvt_pk_bf16_f32 v56, v24, v25
    v_cvt_pk_bf16_f32 v57, v26, v27
    v_cvt_pk_bf16_f32 v58, v28, v29
    v_cvt_pk_bf16_f32 v59, v30, v31
    s_nop 1
    v_permlane16_swap_b32 v56, v58
    v_permlane16_swap_b32 v57, v59
    v_pk_mul_f32 v[40:41], v[32:33], s[86:87]
    v_pk_mul_f32 v[42:43], v[34:35], s[86:87]
    v_pk_mul_f32 v[44:45], v[36:37], s[86:87]
    v_pk_mul_f32 v[46:47], v[38:39], s[86:87]
    v_exp_f32 v40, v40
    v_exp_f32 v41, v41
    v_exp_f32 v42, v42
    v_exp_f32 v43, v43
    v_exp_f32 v44, v44
    v_exp_f32 v45, v45
    v_exp_f32 v46, v46
    v_exp_f32 v47, v47
    v_pk_add_f32 v[40:41], v[40:41], s[84:85]
    v_pk_add_f32 v[42:43], v[42:43], s[84:85]
    v_pk_add_f32 v[44:45], v[44:45], s[84:85]
    v_pk_add_f32 v[46:47], v[46:47], s[84:85]
    v_rcp_f32 v40, v40
    v_rcp_f32 v41, v41
    v_rcp_f32 v42, v42
    v_rcp_f32 v43, v43
    v_rcp_f32 v44, v44
    v_rcp_f32 v45, v45
    v_rcp_f32 v46, v46
    v_rcp_f32 v47, v47
    v_pk_mul_f32 v[32:33], v[32:33], v[40:41]
    v_pk_mul_f32 v[34:35], v[34:35], v[42:43]
    v_pk_mul_f32 v[36:37], v[36:37], v[44:45]
    v_pk_mul_f32 v[38:39], v[38:39], v[46:47]
    v_cvt_pk_bf16_f32 v60, v32, v33
    v_cvt_pk_bf16_f32 v61, v34, v35
    v_cvt_pk_bf16_f32 v62, v36, v37
    v_cvt_pk_bf16_f32 v63, v38, v39
    s_nop 1
    v_permlane16_swap_b32 v60, v62
    v_permlane16_swap_b32 v61, v63
    s_lshl_b32 s48, s45, 1
    s_add_u32 s48, s48, s57
    s_mul_i32 s48, s48, 86
    s_add_u32 s48, s48, s60
    s_mul_i32 s49, s56, 3
    s_add_u32 s48, s48, s49
    s_lshl_b32 s48, s48, 10
    s_add_u32 s48, s48, 7340032
    s_add_u32 s50, s49, 0
    s_add_u32 s51, s48, 0
    s_cmp_lt_u32 s50, s61
    s_cselect_b32 s51, s51, 1073741824
    buffer_store_dwordx4 v[52:55], v2, s[28:31], s51 offen sc1
    s_add_u32 s50, s49, 1
    s_add_u32 s51, s48, 1024
    s_cmp_lt_u32 s50, s61
    s_cselect_b32 s51, s51, 1073741824
    buffer_store_dwordx4 v[56:59], v2, s[28:31], s51 offen sc1
    s_add_u32 s50, s49, 2
    s_add_u32 s51, s48, 2048
    s_cmp_lt_u32 s50, s61
    s_cselect_b32 s51, s51, 1073741824
    buffer_store_dwordx4 v[60:63], v2, s[28:31], s51 offen sc1
    s_waitcnt vmcnt(9)
    v_mfma_f32_32x32x16_bf16 v[16:31], v[88:91], v[8:11], 0
    s_nop 15
    s_nop 3
    v_exp_f32 v16, v16
    v_exp_f32 v17, v17
    s_mov_b64 exec, s[52:53]
    buffer_load_dwordx4 v[128:131], v6, s[40:43], s59 offen sc1
    buffer_load_dwordx4 v[132:135], v6, s[40:43], s59 offen offset:512 sc1
    s_mov_b64 exec, -1
    v_exp_f32 v18, v18
    v_exp_f32 v19, v19
    v_exp_f32 v20, v20
    v_exp_f32 v21, v21
    v_mfma_f32_32x32x16_bf16 v[32:47], v[88:91], v[12:15], 0
    v_exp_f32 v22, v22
    v_exp_f32 v23, v23
    v_cvt_pk_bf16_f32 v48, v16, v17
    v_cvt_pk_bf16_f32 v49, v18, v19
    v_cvt_pk_bf16_f32 v50, v20, v21
    v_cvt_pk_bf16_f32 v51, v22, v23
    v_exp_f32 v24, v24
    v_exp_f32 v25, v25
    v_mfma_f32_32x32x16_bf16 v[56:71], v[104:107], v[48:51], 0
    buffer_load_dwordx4 v[100:103], v2, s[36:39], s59 offen sc1
    v_exp_f32 v26, v26
    v_exp_f32 v27, v27
    v_exp_f32 v28, v28
    v_exp_f32 v29, v29
    v_exp_f32 v30, v30
    v_exp_f32 v31, v31
    v_cvt_pk_bf16_f32 v52, v24, v25
    v_cvt_pk_bf16_f32 v53, v26, v27
    v_cvt_pk_bf16_f32 v54, v28, v29
    v_cvt_pk_bf16_f32 v55, v30, v31
    v_exp_f32 v32, v32
    v_exp_f32 v33, v33
    v_mfma_f32_32x32x16_bf16 v[56:71], v[108:111], v[52:55], v[56:71]
    s_waitcnt vmcnt(9)
    v_exp_f32 v34, v34
    v_exp_f32 v35, v35
    v_exp_f32 v36, v36
    v_exp_f32 v37, v37
    v_mfma_f32_32x32x16_bf16 v[16:31], v[92:95], v[8:11], 0
    s_xor_b32 s59, s58, 4096
    v_exp_f32 v38, v38
    v_exp_f32 v39, v39
    v_cvt_pk_bf16_f32 v48, v32, v33
    v_cvt_pk_bf16_f32 v49, v34, v35
    v_cvt_pk_bf16_f32 v50, v36, v37
    v_cvt_pk_bf16_f32 v51, v38, v39
    v_exp_f32 v40, v40
    v_exp_f32 v41, v41
    v_mfma_f32_32x32x16_bf16 v[72:87], v[104:107], v[48:51], 0
    v_exp_f32 v42, v42
    v_exp_f32 v43, v43
    v_exp_f32 v44, v44
    v_exp_f32 v45, v45
    v_exp_f32 v46, v46
    v_exp_f32 v47, v47
    v_cvt_pk_bf16_f32 v52, v40, v41
    v_cvt_pk_bf16_f32 v53, v42, v43
    v_cvt_pk_bf16_f32 v54, v44, v45
    v_cvt_pk_bf16_f32 v55, v46, v47
    v_exp_f32 v16, v16
    v_exp_f32 v17, v17
    v_mfma_f32_32x32x16_bf16 v[72:87], v[108:111], v[52:55], v[72:87]
    s_mov_b64 exec, s[52:53]
    buffer_load_dwordx4 v[104:107], v6, s[40:43], s59 offen sc1
    buffer_load_dwordx4 v[108:111], v6, s[40:43], s59 offen offset:512 sc1
    s_mov_b64 exec, -1
    v_exp_f32 v18, v18
    v_exp_f32 v19, v19
    v_exp_f32 v20, v20
    v_exp_f32 v21, v21
    v_mfma_f32_32x32x16_bf16 v[32:47], v[92:95], v[12:15], 0
    v_exp_f32 v22, v22
    v_exp_f32 v23, v23
    v_cvt_pk_bf16_f32 v48, v16, v17
    v_cvt_pk_bf16_f32 v49, v18, v19
    v_cvt_pk_bf16_f32 v50, v20, v21
    v_cvt_pk_bf16_f32 v51, v22, v23
    v_exp_f32 v24, v24
    v_exp_f32 v25, v25
    v_mfma_f32_32x32x16_bf16 v[56:71], v[112:115], v[48:51], v[56:71]
    buffer_load_dwordx4 v[88:91], v2, s[36:39], s59 offen sc1
    v_exp_f32 v26, v26
    v_exp_f32 v27, v27
    v_exp_f32 v28, v28
    v_exp_f32 v29, v29
    v_exp_f32 v30, v30
    v_exp_f32 v31, v31
    v_cvt_pk_bf16_f32 v52, v24, v25
    v_cvt_pk_bf16_f32 v53, v26, v27
    v_cvt_pk_bf16_f32 v54, v28, v29
    v_cvt_pk_bf16_f32 v55, v30, v31
    v_exp_f32 v32, v32
    v_exp_f32 v33, v33
    v_mfma_f32_32x32x16_bf16 v[56:71], v[116:119], v[52:55], v[56:71]
    s_waitcnt vmcnt(9)
    v_exp_f32 v34, v34
    v_exp_f32 v35, v35
    v_exp_f32 v36, v36
    v_exp_f32 v37, v37
    v_mfma_f32_32x32x16_bf16 v[16:31], v[96:99], v[8:11], 0
    s_xor_b32 s59, s58, 5120
    v_exp_f32 v38, v38
    v_exp_f32 v39, v39
    v_cvt_pk_bf16_f32 v48, v32, v33
    v_cvt_pk_bf16_f32 v49, v34, v35
    v_cvt_pk_bf16_f32 v50, v36, v37
    v_cvt_pk_bf16_f32 v51, v38, v39
    v_exp_f32 v40, v40
    v_exp_f32 v41, v41
    v_mfma_f32_32x32x16_bf16 v[72:87], v[112:115], v[48:51], v[72:87]
    v_exp_f32 v42, v42
    v_exp_f32 v43, v43
    v_exp_f32 v44, v44
    v_exp_f32 v45, v45
    v_exp_f32 v46, v46
    v_exp_f32 v47, v47
    v_cvt_pk_bf16_f32 v52, v40, v41
    v_cvt_pk_bf16_f32 v53, v42, v43
    v_cvt_pk_bf16_f32 v54, v44, v45
    v_cvt_pk_bf16_f32 v55, v46, v47
    v_exp_f32 v16, v16
    v_exp_f32 v17, v17
    v_mfma_f32_32x32x16_bf16 v[72:87], v[116:119], v[52:55], v[72:87]
    s_mov_b64 exec, s[52:53]
    buffer_load_dwordx4 v[112:115], v6, s[40:43], s59 offen sc1
    buffer_load_dwordx4 v[116:119], v6, s[40:43], s59 offen offset:512 sc1
    s_mov_b64 exec, -1
    v_exp_f32 v18, v18
    v_exp_f32 v19, v19
    v_exp_f32 v20, v20
    v_exp_f32 v21, v21
    v_mfma_f32_32x32x16_bf16 v[32:47], v[96:99], v[12:15], 0
    v_exp_f32 v22, v22
    v_exp_f32 v23, v23
    v_cvt_pk_bf16_f32 v48, v16, v17
    v_cvt_pk_bf16_f32 v49, v18, v19
    v_cvt_pk_bf16_f32 v50, v20, v21
    v_cvt_pk_bf16_f32 v51, v22, v23
    v_exp_f32 v24, v24
    v_exp_f32 v25, v25
    v_mfma_f32_32x32x16_bf16 v[56:71], v[120:123], v[48:51], v[56:71]
    buffer_load_dwordx4 v[92:95], v2, s[36:39], s59 offen sc1
    v_exp_f32 v26, v26
    v_exp_f32 v27, v27
    v_exp_f32 v28, v28
    v_exp_f32 v29, v29
    v_exp_f32 v30, v30
    v_exp_f32 v31, v31
    v_cvt_pk_bf16_f32 v52, v24, v25
    v_cvt_pk_bf16_f32 v53, v26, v27
    v_cvt_pk_bf16_f32 v54, v28, v29
    v_cvt_pk_bf16_f32 v55, v30, v31
    v_exp_f32 v32, v32
    v_exp_f32 v33, v33
    v_mfma_f32_32x32x16_bf16 v[56:71], v[124:127], v[52:55], v[56:71]
    s_waitcnt vmcnt(6)
    v_exp_f32 v34, v34
    v_exp_f32 v35, v35
    v_exp_f32 v36, v36
    v_exp_f32 v37, v37
    v_mfma_f32_32x32x16_bf16 v[16:31], v[100:103], v[8:11], 0
    s_xor_b32 s59, s58, 6144
    v_exp_f32 v38, v38
    v_exp_f32 v39, v39
    v_cvt_pk_bf16_f32 v48, v32, v33
    v_cvt_pk_bf16_f32 v49, v34, v35
    v_cvt_pk_bf16_f32 v50, v36, v37
    v_cvt_pk_bf16_f32 v51, v38, v39
    v_exp_f32 v40, v40
    v_exp_f32 v41, v41
    v_mfma_f32_32x32x16_bf16 v[72:87], v[120:123], v[48:51], v[72:87]
    v_exp_f32 v42, v42
    v_exp_f32 v43, v43
    v_exp_f32 v44, v44
    v_exp_f32 v45, v45
    v_exp_f32 v46, v46
    v_exp_f32 v47, v47
    v_cvt_pk_bf16_f32 v52, v40, v41
    v_cvt_pk_bf16_f32 v53, v42, v43
    v_cvt_pk_bf16_f32 v54, v44, v45
    v_cvt_pk_bf16_f32 v55, v46, v47
    v_exp_f32 v16, v16
    v_exp_f32 v17, v17
    v_mfma_f32_32x32x16_bf16 v[72:87], v[124:127], v[52:55], v[72:87]
    s_mov_b64 exec, s[52:53]
    buffer_load_dwordx4 v[120:123], v6, s[40:43], s59 offen sc1
    buffer_load_dwordx4 v[124:127], v6, s[40:43], s59 offen offset:512 sc1
    s_mov_b64 exec, -1
    v_exp_f32 v18, v18
    v_exp_f32 v19, v19
    v_exp_f32 v20, v20
    v_exp_f32 v21, v21
    v_mfma_f32_32x32x16_bf16 v[32:47], v[100:103], v[12:15], 0
    v_exp_f32 v22, v22
    v_exp_f32 v23, v23
    v_cvt_pk_bf16_f32 v48, v16, v17
    v_cvt_pk_bf16_f32 v49, v18, v19
    v_cvt_pk_bf16_f32 v50, v20, v21
    v_cvt_pk_bf16_f32 v51, v22, v23
    v_exp_f32 v24, v24
    v_exp_f32 v25, v25
    v_mfma_f32_32x32x16_bf16 v[56:71], v[128:131], v[48:51], v[56:71]
    buffer_load_dwordx4 v[96:99], v2, s[36:39], s59 offen sc1
    v_exp_f32 v26, v26
    v_exp_f32 v27, v27
    v_exp_f32 v28, v28
    v_exp_f32 v29, v29
    v_exp_f32 v30, v30
    v_exp_f32 v31, v31
    v_cvt_pk_bf16_f32 v52, v24, v25
    v_cvt_pk_bf16_f32 v53, v26, v27
    v_cvt_pk_bf16_f32 v54, v28, v29
    v_cvt_pk_bf16_f32 v55, v30, v31
    v_exp_f32 v32, v32
    v_exp_f32 v33, v33
    v_mfma_f32_32x32x16_bf16 v[56:71], v[132:135], v[52:55], v[56:71]
    s_waitcnt vmcnt(6)
    v_exp_f32 v34, v34
    v_exp_f32 v35, v35
    v_exp_f32 v36, v36
    v_exp_f32 v37, v37
    v_mfma_f32_32x32x16_bf16 v[16:31], v[88:91], v[8:11], 0
    s_xor_b32 s59, s58, 7168
    v_exp_f32 v38, v38
    v_exp_f32 v39, v39
    v_cvt_pk_bf16_f32 v48, v32, v33
    v_cvt_pk_bf16_f32 v49, v34, v35
    v_cvt_pk_bf16_f32 v50, v36, v37
    v_cvt_pk_bf16_f32 v51, v38, v39
    v_exp_f32 v40, v40
    v_exp_f32 v41, v41
    v_mfma_f32_32x32x16_bf16 v[72:87], v[128:131], v[48:51], v[72:87]
    v_exp_f32 v42, v42
    v_exp_f32 v43, v43
    v_exp_f32 v44, v44
    v_exp_f32 v45, v45
    v_exp_f32 v46, v46
    v_exp_f32 v47, v47
    v_cvt_pk_bf16_f32 v52, v40, v41
    v_cvt_pk_bf16_f32 v53, v42, v43
    v_cvt_pk_bf16_f32 v54, v44, v45
    v_cvt_pk_bf16_f32 v55, v46, v47
    v_exp_f32 v16, v16
    v_exp_f32 v17, v17
    v_mfma_f32_32x32x16_bf16 v[72:87], v[132:135], v[52:55], v[72:87]
    s_mov_b64 exec, s[52:53]
    buffer_load_dwordx4 v[128:131], v6, s[40:43], s59 offen sc1
    buffer_load_dwordx4 v[132:135], v6, s[40:43], s59 offen offset:512 sc1
    s_mov_b64 exec, -1
    v_exp_f32 v18, v18
    v_exp_f32 v19, v19
    v_exp_f32 v20, v20
    v_exp_f32 v21, v21
    v_mfma_f32_32x32x16_bf16 v[32:47], v[88:91], v[12:15], 0
    s_cmp_ge_u32 s46, 4
    s_cbranch_scc0 L_prio_b
    s_setprio 1
L_prio_b:
    v_exp_f32 v22, v22
    v_exp_f32 v23, v23
    v_cvt_pk_bf16_f32 v48, v16, v17
    v_cvt_pk_bf16_f32 v49, v18, v19
    v_cvt_pk_bf16_f32 v50, v20, v21
    v_cvt_pk_bf16_f32 v51, v22, v23
    v_exp_f32 v24, v24
    v_exp_f32 v25, v25
    v_mfma_f32_32x32x16_bf16 v[56:71], v[104:107], v[48:51], v[56:71]
    buffer_load_dwordx4 v[100:103], v2, s[36:39], s59 offen sc1
    v_exp_f32 v26, v26
    v_exp_f32 v27, v27
    v_exp_f32 v28, v28
    v_exp_f32 v29, v29
    v_exp_f32 v30, v30
    v_exp_f32 v31, v31
    v_cvt_pk_bf16_f32 v52, v24, v25
    v_cvt_pk_bf16_f32 v53, v26, v27
    v_cvt_pk_bf16_f32 v54, v28, v29
    v_cvt_pk_bf16_f32 v55, v30, v31
    v_exp_f32 v32, v32
    v_exp_f32 v33, v33
    v_mfma_f32_32x32x16_bf16 v[56:71], v[108:111], v[52:55], v[56:71]
    s_waitcnt vmcnt(6)
    v_exp_f32 v34, v34
    v_exp_f32 v35, v35
    v_exp_f32 v36, v36
    v_exp_f32 v37, v37
    v_mfma_f32_32x32x16_bf16 v[16:31], v[92:95], v[8:11], 0
    s_xor_b32 s59, s58, 8192
    v_exp_f32 v38, v38
    v_exp_f32 v39, v39
    v_cvt_pk_bf16_f32 v48, v32, v33
    v_cvt_pk_bf16_f32 v49, v34, v35
    v_cvt_pk_bf16_f32 v50, v36, v37
    v_cvt_pk_bf16_f32 v51, v38, v39
    v_exp_f32 v40, v40
    v_exp_f32 v41, v41
    v_mfma_f32_32x32x16_bf16 v[72:87], v[104:107], v[48:51], v[72:87]
    v_mov_b32 v3, 163584
    v_mov_b32 v4, 1
    s_mov_b64 exec, 1
    ds_add_rtn_u32 v4, v3, v4
    s_waitcnt lgkmcnt(0)
    v_readfirstlane_b32 s48, v4
    s_mov_b64 exec, -1
    s_nop 2
    s_cmp_eq_u32 s48, 7
    s_cselect_b32 s49, 0, 1073741824
    s_lshl_b32 s48, s45, 5
    s_add_u32 s48, s48, s44
    s_lshl_b32 s48, s48, 2
    s_add_u32 s48, s48, 16384
    s_add_u32 s48, s48, s49
    v_mov_b32 v3, s47
    v_mov_b32 v4, 0
    s_mov_b64 exec, 1
    buffer_store_dword v3, v4, s[28:31], s48 offen sc1
    s_mov_b64 exec, -1
    s_lshl_b32 s86, s46, 10
    v_exp_f32 v42, v42
    v_exp_f32 v43, v43
    v_exp_f32 v44, v44
    v_exp_f32 v45, v45
    v_exp_f32 v46, v46
    v_exp_f32 v47, v47
    v_cvt_pk_bf16_f32 v52, v40, v41
    v_cvt_pk_bf16_f32 v53, v42, v43
    v_cvt_pk_bf16_f32 v54, v44, v45
    v_cvt_pk_bf16_f32 v55, v46, v47
    v_exp_f32 v16, v16
    v_exp_f32 v17, v17
    v_mfma_f32_32x32x16_bf16 v[72:87], v[108:111], v[52:55], v[72:87]
    s_mov_b64 exec, s[52:53]
    buffer_load_dwordx4 v[104:107], v6, s[40:43], s59 offen sc1
    buffer_load_dwordx4 v[108:111], v6, s[40:43], s59 offen offset:512 sc1
    s_mov_b64 exec, -1
    v_exp_f32 v18, v18
    v_exp_f32 v19, v19
    v_exp_f32 v20, v20
    v_exp_f32 v21, v21
    v_mfma_f32_32x32x16_bf16 v[32:47], v[92:95], v[12:15], 0
    v_exp_f32 v22, v22
    v_exp_f32 v23, v23
    v_cvt_pk_bf16_f32 v48, v16, v17
    v_cvt_pk_bf16_f32 v49, v18, v19
    v_cvt_pk_bf16_f32 v50, v20, v21
    v_cvt_pk_bf16_f32 v51, v22, v23
    v_exp_f32 v24, v24
    v_exp_f32 v25, v25
    v_mfma_f32_32x32x16_bf16 v[56:71], v[112:115], v[48:51], v[56:71]
    buffer_load_dwordx4 v[88:91], v2, s[36:39], s59 offen sc1
    v_exp_f32 v26, v26
    v_exp_f32 v27, v27
    v_exp_f32 v28, v28
    v_exp_f32 v29, v29
    v_exp_f32 v30, v30
    v_exp_f32 v31, v31
    v_cvt_pk_bf16_f32 v52, v24, v25
    v_cvt_pk_bf16_f32 v53, v26, v27
    v_cvt_pk_bf16_f32 v54, v28, v29
    v_cvt_pk_bf16_f32 v55, v30, v31
    v_exp_f32 v32, v32
    v_exp_f32 v33, v33
    v_mfma_f32_32x32x16_bf16 v[56:71], v[116:119], v[52:55], v[56:71]
    s_waitcnt vmcnt(7)
    v_exp_f32 v34, v34
    v_exp_f32 v35, v35
    v_exp_f32 v36, v36
    v_exp_f32 v37, v37
    v_mfma_f32_32x32x16_bf16 v[16:31], v[96:99], v[8:11], 0
    s_xor_b32 s59, s58, 9216
    v_exp_f32 v38, v38
    v_exp_f32 v39, v39
    v_cvt_pk_bf16_f32 v48, v32, v33
    v_cvt_pk_bf16_f32 v49, v34, v35
    v_cvt_pk_bf16_f32 v50, v36, v37
    v_cvt_pk_bf16_f32 v51, v38, v39
    v_exp_f32 v40, v40
    v_exp_f32 v41, v41
    v_mfma_f32_32x32x16_bf16 v[72:87], v[112:115], v[48:51], v[72:87]
    v_exp_f32 v42, v42
    v_exp_f32 v43, v43
    v_exp_f32 v44, v44
    v_exp_f32 v45, v45
    v_exp_f32 v46, v46
    v_exp_f32 v47, v47
    v_cvt_pk_bf16_f32 v52, v40, v41
    v_cvt_pk_bf16_f32 v53, v42, v43
    v_cvt_pk_bf16_f32 v54, v44, v45
    v_cvt_pk_bf16_f32 v55, v46, v47
    v_exp_f32 v16, v16
    v_exp_f32 v17, v17
    v_mfma_f32_32x32x16_bf16 v[72:87], v[116:119], v[52:55], v[72:87]
    s_mov_b64 exec, s[52:53]
    buffer_load_dwordx4 v[112:115], v6, s[40:43], s59 offen sc1
    buffer_load_dwordx4 v[116:119], v6, s[40:43], s59 offen offset:512 sc1
    s_mov_b64 exec, -1
    v_exp_f32 v18, v18
    v_exp_f32 v19, v19
    v_exp_f32 v20, v20
    v_exp_f32 v21, v21
    v_mfma_f32_32x32x16_bf16 v[32:47], v[96:99], v[12:15], 0
    v_exp_f32 v22, v22
    v_exp_f32 v23, v23
    v_cvt_pk_bf16_f32 v48, v16, v17
    v_cvt_pk_bf16_f32 v49, v18, v19
    v_cvt_pk_bf16_f32 v50, v20, v21
    v_cvt_pk_bf16_f32 v51, v22, v23
    v_exp_f32 v24, v24
    v_exp_f32 v25, v25
    v_mfma_f32_32x32x16_bf16 v[56:71], v[120:123], v[48:51], v[56:71]
    buffer_load_dwordx4 v[92:95], v2, s[36:39], s59 offen sc1
    v_exp_f32 v26, v26
    v_exp_f32 v27, v27
    v_exp_f32 v28, v28
    v_exp_f32 v29, v29
    v_exp_f32 v30, v30
    v_exp_f32 v31, v31
    v_cvt_pk_bf16_f32 v52, v24, v25
    v_cvt_pk_bf16_f32 v53, v26, v27
    v_cvt_pk_bf16_f32 v54, v28, v29
    v_cvt_pk_bf16_f32 v55, v30, v31
    v_exp_f32 v32, v32
    v_exp_f32 v33, v33
    v_mfma_f32_32x32x16_bf16 v[56:71], v[124:127], v[52:55], v[56:71]
    s_waitcnt vmcnt(7)
    v_exp_f32 v34, v34
    v_exp_f32 v35, v35
    v_exp_f32 v36, v36
    v_exp_f32 v37, v37
    v_mfma_f32_32x32x16_bf16 v[16:31], v[100:103], v[8:11], 0
    s_xor_b32 s59, s58, 10240
    v_exp_f32 v38, v38
    v_exp_f32 v39, v39
    v_cvt_pk_bf16_f32 v48, v32, v33
    v_cvt_pk_bf16_f32 v49, v34, v35
    v_cvt_pk_bf16_f32 v50, v36, v37
    v_cvt_pk_bf16_f32 v51, v38, v39
    v_exp_f32 v40, v40
    v_exp_f32 v41, v41
    v_mfma_f32_32x32x16_bf16 v[72:87], v[120:123], v[48:51], v[72:87]
    v_exp_f32 v42, v42
    v_exp_f32 v43, v43
    v_exp_f32 v44, v44
    v_exp_f32 v45, v45
    v_exp_f32 v46, v46
    v_exp_f32 v47, v47
    v_cvt_pk_bf16_f32 v52, v40, v41
    v_cvt_pk_bf16_f32 v53, v42, v43
    v_cvt_pk_bf16_f32 v54, v44, v45
    v_cvt_pk_bf16_f32 v55, v46, v47
    v_exp_f32 v16, v16
    v_exp_f32 v17, v17
    v_mfma_f32_32x32x16_bf16 v[72:87], v[124:127], v[52:55], v[72:87]
    s_mov_b64 exec, s[52:53]
    buffer_load_dwordx4 v[120:123], v6, s[40:43], s59 offen sc1
    buffer_load_dwordx4 v[124:127], v6, s[40:43], s59 offen offset:512 sc1
    s_mov_b64 exec, -1
    v_exp_f32 v18, v18
    v_exp_f32 v19, v19
    v_exp_f32 v20, v20
    v_exp_f32 v21, v21
    v_mfma_f32_32x32x16_bf16 v[32:47], v[100:103], v[12:15], 0
    s_lshl_b32 s90, s45, 7
    s_add_u32 s90, s90, 16384
    s_mov_b64 exec, 255
    buffer_load_dword v248, v252, s[28:31], s90 offen sc1
    s_mov_b64 exec, -1
    v_exp_f32 v22, v22
    v_exp_f32 v23, v23
    v_cvt_pk_bf16_f32 v48, v16, v17
    v_cvt_pk_bf16_f32 v49, v18, v19
    v_cvt_pk_bf16_f32 v50, v20, v21
    v_cvt_pk_bf16_f32 v51, v22, v23
    v_exp_f32 v24, v24
    v_exp_f32 v25, v25
    v_mfma_f32_32x32x16_bf16 v[56:71], v[128:131], v[48:51], v[56:71]
    buffer_load_dwordx4 v[96:99], v2, s[36:39], s59 offen sc1
    v_exp_f32 v26, v26
    v_exp_f32 v27, v27
    v_exp_f32 v28, v28
    v_exp_f32 v29, v29
    v_exp_f32 v30, v30
    v_exp_f32 v31, v31
    v_cvt_pk_bf16_f32 v52, v24, v25
    v_cvt_pk_bf16_f32 v53, v26, v27
    v_cvt_pk_bf16_f32 v54, v28, v29
    v_cvt_pk_bf16_f32 v55, v30, v31
    v_exp_f32 v32, v32
    v_exp_f32 v33, v33
    v_mfma_f32_32x32x16_bf16 v[56:71], v[132:135], v[52:55], v[56:71]
    s_waitcnt vmcnt(7)
    v_exp_f32 v34, v34
    v_exp_f32 v35, v35
    v_exp_f32 v36, v36
    v_exp_f32 v37, v37
    v_mfma_f32_32x32x16_bf16 v[16:31], v[88:91], v[8:11], 0
    s_xor_b32 s59, s58, 11264
    v_exp_f32 v38, v38
    v_exp_f32 v39, v39
    v_cvt_pk_bf16_f32 v48, v32, v33
    v_cvt_pk_bf16_f32 v49, v34, v35
    v_cvt_pk_bf16_f32 v50, v36, v37
    v_cvt_pk_bf16_f32 v51, v38, v39
    v_exp_f32 v40, v40
    v_exp_f32 v41, v41
    v_mfma_f32_32x32x16_bf16 v[72:87], v[128:131], v[48:51], v[72:87]
    v_exp_f32 v42, v42
    v_exp_f32 v43, v43
    v_exp_f32 v44, v44
    v_exp_f32 v45, v45
    v_exp_f32 v46, v46
    v_exp_f32 v47, v47
    v_cvt_pk_bf16_f32 v52, v40, v41
    v_cvt_pk_bf16_f32 v53, v42, v43
    v_cvt_pk_bf16_f32 v54, v44, v45
    v_cvt_pk_bf16_f32 v55, v46, v47
    v_exp_f32 v16, v16
    v_exp_f32 v17, v17
    v_mfma_f32_32x32x16_bf16 v[72:87], v[132:135], v[52:55], v[72:87]
    s_mov_b64 exec, s[52:53]
    buffer_load_dwordx4 v[128:131], v6, s[40:43], s59 offen sc1
    buffer_load_dwordx4 v[132:135], v6, s[40:43], s59 offen offset:512 sc1
    s_mov_b64 exec, -1
    v_exp_f32 v18, v18
    v_exp_f32 v19, v19
    v_exp_f32 v20, v20
    v_exp_f32 v21, v21
    v_mfma_f32_32x32x16_bf16 v[32:47], v[88:91], v[12:15], 0
    s_lshl_b32 s85, s62, 7
    s_add_u32 s85, s85, 16384
    s_mov_b64 exec, 255
    buffer_load_dword v251, v252, s[28:31], s85 offen sc1
    s_mov_b64 exec, -1
    v_exp_f32 v22, v22
    v_exp_f32 v23, v23
    v_cvt_pk_bf16_f32 v48, v16, v17
    v_cvt_pk_bf16_f32 v49, v18, v19
    v_cvt_pk_bf16_f32 v50, v20, v21
    v_cvt_pk_bf16_f32 v51, v22, v23
    v_exp_f32 v24, v24
    v_exp_f32 v25, v25
    v_mfma_f32_32x32x16_bf16 v[56:71], v[104:107], v[48:51], v[56:71]
    buffer_load_dwordx4 v[100:103], v2, s[36:39], s59 offen sc1
    v_exp_f32 v26, v26
    v_exp_f32 v27, v27
    v_exp_f32 v28, v28
    v_exp_f32 v29, v29
    v_exp_f32 v30, v30
    v_exp_f32 v31, v31
    v_cvt_pk_bf16_f32 v52, v24, v25
    v_cvt_pk_bf16_f32 v53, v26, v27
    v_cvt_pk_bf16_f32 v54, v28, v29
    v_cvt_pk_bf16_f32 v55, v30, v31
    v_exp_f32 v32, v32
    v_exp_f32 v33, v33
    v_mfma_f32_32x32x16_bf16 v[56:71], v[108:111], v[52:55], v[56:71]
    s_waitcnt vmcnt(8)
    v_exp_f32 v34, v34
    v_exp_f32 v35, v35
    v_exp_f32 v36, v36
    v_exp_f32 v37, v37
    v_mfma_f32_32x32x16_bf16 v[16:31], v[92:95], v[8:11], 0
    s_xor_b32 s59, s58, 12288
    v_exp_f32 v38, v38
    v_exp_f32 v39, v39
    v_cvt_pk_bf16_f32 v48, v32, v33
    v_cvt_pk_bf16_f32 v49, v34, v35
    v_cvt_pk_bf16_f32 v50, v36, v37
    v_cvt_pk_bf16_f32 v51, v38, v39
    v_exp_f32 v40, v40
    v_exp_f32 v41, v41
    v_mfma_f32_32x32x16_bf16 v[72:87], v[104:107], v[48:51], v[72:87]
    v_exp_f32 v42, v42
    v_exp_f32 v43, v43
    v_exp_f32 v44, v44
    v_exp_f32 v45, v45
    v_exp_f32 v46, v46
    v_exp_f32 v47, v47
    v_cvt_pk_bf16_f32 v52, v40, v41
    v_cvt_pk_bf16_f32 v53, v42, v43
    v_cvt_pk_bf16_f32 v54, v44, v45
    v_cvt_pk_bf16_f32 v55, v46, v47
    v_exp_f32 v16, v16
    v_exp_f32 v17, v17
    v_mfma_f32_32x32x16_bf16 v[72:87], v[108:111], v[52:55], v[72:87]
    s_mov_b64 exec, s[52:53]
    buffer_load_dwordx4 v[104:107], v6, s[40:43], s59 offen sc1
    buffer_load_dwordx4 v[108:111], v6, s[40:43], s59 offen offset:512 sc1
    s_mov_b64 exec, -1
    v_exp_f32 v18, v18
    v_exp_f32 v19, v19
    v_exp_f32 v20, v20
    v_exp_f32 v21, v21
    v_mfma_f32_32x32x16_bf16 v[32:47], v[92:95], v[12:15], 0
    s_waitcnt vmcnt(7)
    s_mov_b64 exec, 255
    v_cmp_ne_u32 vcc, s47, v248
    s_cbranch_vccz L_polled_g
    s_mov_b32 s84, 0
L_poll_g:
    s_sleep 1
    buffer_load_dword v248, v252, s[28:31], s90 offen sc1
    s_add_u32 s84, s84, 1
    s_waitcnt vmcnt(0)
    v_cmp_ne_u32 vcc, s47, v248
    s_cmp_ge_u32 s84, 400000
    s_cbranch_scc1 L_polled_g
    s_cbranch_vccnz L_poll_g
L_polled_g:
    s_mov_b64 exec, -1
    s_lshl_b32 s48, s45, 6
    s_lshl_b32 s49, s57, 5
    s_add_u32 s48, s48, s49
    s_lshl_b32 s48, s48, 2
    s_add_u32 s48, s48, 32768
    v_and_b32 v5, 31, v1
    v_lshlrev_b32 v5, 2, v5
    buffer_load_dword v249, v5, s[28:31], s48 offen sc1
    v_exp_f32 v22, v22
    v_exp_f32 v23, v23
    v_cvt_pk_bf16_f32 v48, v16, v17
    v_cvt_pk_bf16_f32 v49, v18, v19
    v_cvt_pk_bf16_f32 v50, v20, v21
    v_cvt_pk_bf16_f32 v51, v22, v23
    v_exp_f32 v24, v24
    v_exp_f32 v25, v25
    v_mfma_f32_32x32x16_bf16 v[56:71], v[112:115], v[48:51], v[56:71]
    buffer_load_dwordx4 v[88:91], v2, s[36:39], s59 offen sc1
    v_exp_f32 v26, v26
    v_exp_f32 v27, v27
    v_exp_f32 v28, v28
    v_exp_f32 v29, v29
    v_exp_f32 v30, v30
    v_exp_f32 v31, v31
    v_cvt_pk_bf16_f32 v52, v24, v25
    v_cvt_pk_bf16_f32 v53, v26, v27
    v_cvt_pk_bf16_f32 v54, v28, v29
    v_cvt_pk_bf16_f32 v55, v30, v31
    v_exp_f32 v32, v32
    v_exp_f32 v33, v33
    v_mfma_f32_32x32x16_bf16 v[56:71], v[116:119], v[52:55], v[56:71]
    s_waitcnt vmcnt(8)
    v_exp_f32 v34, v34
    v_exp_f32 v35, v35
    v_exp_f32 v36, v36
    v_exp_f32 v37, v37
    v_mfma_f32_32x32x16_bf16 v[16:31], v[96:99], v[8:11], 0
    s_xor_b32 s59, s58, 13312
    v_exp_f32 v38, v38
    v_exp_f32 v39, v39
    v_cvt_pk_bf16_f32 v48, v32, v33
    v_cvt_pk_bf16_f32 v49, v34, v35
    v_cvt_pk_bf16_f32 v50, v36, v37
    v_cvt_pk_bf16_f32 v51, v38, v39
    v_exp_f32 v40, v40
    v_exp_f32 v41, v41
    v_mfma_f32_32x32x16_bf16 v[72:87], v[112:115], v[48:51], v[72:87]
    v_exp_f32 v42, v42
    v_exp_f32 v43, v43
    v_exp_f32 v44, v44
    v_exp_f32 v45, v45
    v_exp_f32 v46, v46
    v_exp_f32 v47, v47
    v_cvt_pk_bf16_f32 v52, v40, v41
    v_cvt_pk_bf16_f32 v53, v42, v43
    v_cvt_pk_bf16_f32 v54, v44, v45
    v_cvt_pk_bf16_f32 v55, v46, v47
    v_exp_f32 v16, v16
    v_exp_f32 v17, v17
    v_mfma_f32_32x32x16_bf16 v[72:87], v[116:119], v[52:55], v[72:87]
    s_mov_b64 exec, s[52:53]
    buffer_load_dwordx4 v[112:115], v6, s[40:43], s59 offen sc1
    buffer_load_dwordx4 v[116:119], v6, s[40:43], s59 offen offset:512 sc1
    s_mov_b64 exec, -1
    v_exp_f32 v18, v18
    v_exp_f32 v19, v19
    v_exp_f32 v20, v20
    v_exp_f32 v21, v21
    v_mfma_f32_32x32x16_bf16 v[32:47], v[96:99], v[12:15], 0
    s_waitcnt vmcnt(7)
    s_mov_b64 exec, 255
    v_cmp_ne_u32 vcc, s47, v251
    s_cbranch_vccz L_polled_h
    s_mov_b32 s84, 0
L_poll_h:
    s_sleep 1
    buffer_load_dword v251, v252, s[28:31], s85 offen sc1
    s_add_u32 s84, s84, 1
    s_waitcnt vmcnt(0)
    v_cmp_ne_u32 vcc, s47, v251
    s_cmp_ge_u32 s84, 400000
    s_cbranch_scc1 L_polled_h
    s_cbranch_vccnz L_poll_h
L_polled_h:
    s_mov_b64 exec, -1
    s_lshl_b32 s85, s62, 1
    s_add_u32 s85, s85, s57
    s_mul_i32 s85, s85, 86
    s_add_u32 s85, s85, s56
    s_lshl_b32 s85, s85, 10
    s_add_u32 s85, s85, 7340032
    v_exp_f32 v22, v22
    v_exp_f32 v23, v23
    v_cvt_pk_bf16_f32 v48, v16, v17
    v_cvt_pk_bf16_f32 v49, v18, v19
    v_cvt_pk_bf16_f32 v50, v20, v21
    v_cvt_pk_bf16_f32 v51, v22, v23
    v_exp_f32 v24, v24
    v_exp_f32 v25, v25
    v_mfma_f32_32x32x16_bf16 v[56:71], v[120:123], v[48:51], v[56:71]
    buffer_load_dwordx4 v[92:95], v2, s[36:39], s59 offen sc1
    v_exp_f32 v26, v26
    v_exp_f32 v27, v27
    v_exp_f32 v28, v28
    v_exp_f32 v29, v29
    v_exp_f32 v30, v30
    v_exp_f32 v31, v31
    v_cvt_pk_bf16_f32 v52, v24, v25
    v_cvt_pk_bf16_f32 v53, v26, v27
    v_cvt_pk_bf16_f32 v54, v28, v29
    v_cvt_pk_bf16_f32 v55, v30, v31
    v_exp_f32 v32, v32
    v_exp_f32 v33, v33
    v_mfma_f32_32x32x16_bf16 v[56:71], v[124:127], v[52:55], v[56:71]
    s_waitcnt vmcnt(7)
    v_exp_f32 v34, v34
    v_exp_f32 v35, v35
    v_exp_f32 v36, v36
    v_exp_f32 v37, v37
    v_mfma_f32_32x32x16_bf16 v[16:31], v[100:103], v[8:11], 0
    s_xor_b32 s59, s58, 14336
    v_exp_f32 v38, v38
    v_exp_f32 v39, v39
    v_cvt_pk_bf16_f32 v48, v32, v33
    v_cvt_pk_bf16_f32 v49, v34, v35
    v_cvt_pk_bf16_f32 v50, v36, v37
    v_cvt_pk_bf16_f32 v51, v38, v39
    v_exp_f32 v40, v40
    v_exp_f32 v41, v41
    v_mfma_f32_32x32x16_bf16 v[72:87], v[120:123], v[48:51], v[72:87]
    s_add_u32 m0, s86, 0
    s_mov_b32 s87, 0
    buffer_load_dwordx4 v241, s[16:19], s87 offen lds
    v_exp_f32 v42, v42
    v_exp_f32 v43, v43
    v_exp_f32 v44, v44
    v_exp_f32 v45, v45
    v_exp_f32 v46, v46
    v_exp_f32 v47, v47
    v_cvt_pk_bf16_f32 v52, v40, v41
    v_cvt_pk_bf16_f32 v53, v42, v43
    v_cvt_pk_bf16_f32 v54, v44, v45
    v_cvt_pk_bf16_f32 v55, v46, v47
    v_exp_f32 v16, v16
    v_exp_f32 v17, v17
    v_mfma_f32_32x32x16_bf16 v[72:87], v[124:127], v[52:55], v[72:87]
    s_mov_b64 exec, s[52:53]
    buffer_load_dwordx4 v[120:123], v6, s[40:43], s59 offen sc1
    buffer_load_dwordx4 v[124:127], v6, s[40:43], s59 offen offset:512 sc1
    s_mov_b64 exec, -1
    v_exp_f32 v18, v18
    v_exp_f32 v19, v19
    v_exp_f32 v20, v20
    v_exp_f32 v21, v21
    v_mfma_f32_32x32x16_bf16 v[32:47], v[100:103], v[12:15], 0
    s_add_u32 s87, s85, 0
    buffer_load_dwordx4 v[136:139], v2, s[28:31], s87 offen sc1
    v_exp_f32 v22, v22
    v_exp_f32 v23, v23
    v_cvt_pk_bf16_f32 v48, v16, v17
    v_cvt_pk_bf16_f32 v49, v18, v19
    v_cvt_pk_bf16_f32 v50, v20, v21
    v_cvt_pk_bf16_f32 v51, v22, v23
    v_exp_f32 v24, v24
    v_exp_f32 v25, v25
    v_mfma_f32_32x32x16_bf16 v[56:71], v[128:131], v[48:51], v[56:71]
    buffer_load_dwordx4 v[96:99], v2, s[36:39], s59 offen sc1
    v_exp_f32 v26, v26
    v_exp_f32 v27, v27
    v_exp_f32 v28, v28
    v_exp_f32 v29, v29
    v_exp_f32 v30, v30
    v_exp_f32 v31, v31
    v_cvt_pk_bf16_f32 v52, v24, v25
    v_cvt_pk_bf16_f32 v53, v26, v27
    v_cvt_pk_bf16_f32 v54, v28, v29
    v_cvt_pk_bf16_f32 v55, v30, v31
    v_exp_f32 v32, v32
    v_exp_f32 v33, v33
    v_mfma_f32_32x32x16_bf16 v[56:71], v[132:135], v[52:55], v[56:71]
    s_waitcnt vmcnt(8)
    v_exp_f32 v34, v34
    v_exp_f32 v35, v35
    v_exp_f32 v36, v36
    v_exp_f32 v37, v37
    v_mfma_f32_32x32x16_bf16 v[16:31], v[88:91], v[8:11], 0
    s_xor_b32 s59, s58, 15360
    v_exp_f32 v38, v38
    v_exp_f32 v39, v39
    v_cvt_pk_bf16_f32 v48, v32, v33
    v_cvt_pk_bf16_f32 v49, v34, v35
    v_cvt_pk_bf16_f32 v50, v36, v37
    v_cvt_pk_bf16_f32 v51, v38, v39
    v_exp_f32 v40, v40
    v_exp_f32 v41, v41
    v_mfma_f32_32x32x16_bf16 v[72:87], v[128:131], v[48:51], v[72:87]
    s_add_u32 m0, s86, 8192
    s_mov_b32 s87, 65536
    buffer_load_dwordx4 v241, s[16:19], s87 offen lds
    v_exp_f32 v42, v42
    v_exp_f32 v43, v43
    v_exp_f32 v44, v44
    v_exp_f32 v45, v45
    v_exp_f32 v46, v46
    v_exp_f32 v47, v47
    v_cvt_pk_bf16_f32 v52, v40, v41
    v_cvt_pk_bf16_f32 v53, v42, v43
    v_cvt_pk_bf16_f32 v54, v44, v45
    v_cvt_pk_bf16_f32 v55, v46, v47
    v_exp_f32 v16, v16
    v_exp_f32 v17, v17
    v_mfma_f32_32x32x16_bf16 v[72:87], v[132:135], v[52:55], v[72:87]
    s_mov_b64 exec, s[52:53]
    buffer_load_dwordx4 v[128:131], v6, s[40:43], s59 offen sc1
    buffer_load_dwordx4 v[132:135], v6, s[40:43], s59 offen offset:512 sc1
    s_mov_b64 exec, -1
    v_exp_f32 v18, v18
    v_exp_f32 v19, v19
    v_exp_f32 v20, v20
    v_exp_f32 v21, v21
    v_mfma_f32_32x32x16_bf16 v[32:47], v[88:91], v[12:15], 0
    s_add_u32 s87, s85, 4096
    buffer_load_dwordx4 v[140:143], v2, s[28:31], s87 offen sc1
    v_exp_f32 v22, v22
    v_exp_f32 v23, v23
    v_cvt_pk_bf16_f32 v48, v16, v17
    v_cvt_pk_bf16_f32 v49, v18, v19
    v_cvt_pk_bf16_f32 v50, v20, v21
    v_cvt_pk_bf16_f32 v51, v22, v23
    v_exp_f32 v24, v24
    v_exp_f32 v25, v25
    v_mfma_f32_32x32x16_bf16 v[56:71], v[104:107], v[48:51], v[56:71]
    buffer_load_dwordx4 v[100:103], v2, s[36:39], s59 offen sc1
    v_exp_f32 v26, v26
    v_exp_f32 v27, v27
    v_exp_f32 v28, v28
    v_exp_f32 v29, v29
    v_exp_f32 v30, v30
    v_exp_f32 v31, v31
    v_cvt_pk_bf16_f32 v52, v24, v25
    v_cvt_pk_bf16_f32 v53, v26, v27
    v_cvt_pk_bf16_f32 v54, v28, v29
    v_cvt_pk_bf16_f32 v55, v30, v31
    v_exp_f32 v32, v32
    v_exp_f32 v33, v33
    v_mfma_f32_32x32x16_bf16 v[56:71], v[108:111], v[52:55], v[56:71]
    s_waitcnt vmcnt(10)
    v_exp_f32 v34, v34
    v_exp_f32 v35, v35
    v_exp_f32 v36, v36
    v_exp_f32 v37, v37
    v_mfma_f32_32x32x16_bf16 v[16:31], v[92:95], v[8:11], 0
    s_xor_b32 s59, s58, 16384
    v_exp_f32 v38, v38
    v_exp_f32 v39, v39
    v_cvt_pk_bf16_f32 v48, v32, v33
    v_cvt_pk_bf16_f32 v49, v34, v35
    v_cvt_pk_bf16_f32 v50, v36, v37
    v_cvt_pk_bf16_f32 v51, v38, v39
    v_exp_f32 v40, v40
    v_exp_f32 v41, v41
    v_mfma_f32_32x32x16_bf16 v[72:87], v[104:107], v[48:51], v[72:87]
    s_add_u32 m0, s86, 16384
    s_mov_b32 s87, 131072
    buffer_load_dwordx4 v241, s[16:19], s87 offen lds
    v_exp_f32 v42, v42
    v_exp_f32 v43, v43
    v_exp_f32 v44, v44
    v_exp_f32 v45, v45
    v_exp_f32 v46, v46
    v_exp_f32 v47, v47
    v_cvt_pk_bf16_f32 v52, v40, v41
    v_cvt_pk_bf16_f32 v53, v42, v43
    v_cvt_pk_bf16_f32 v54, v44, v45
    v_cvt_pk_bf16_f32 v55, v46, v47
    v_exp_f32 v16, v16
    v_exp_f32 v17, v17
    v_mfma_f32_32x32x16_bf16 v[72:87], v[108:111], v[52:55], v[72:87]
    s_mov_b64 exec, s[52:53]
    buffer_load_dwordx4 v[104:107], v6, s[40:43], s59 offen sc1
    buffer_load_dwordx4 v[108:111], v6, s[40:43], s59 offen offset:512 sc1
    s_mov_b64 exec, -1
    v_exp_f32 v18, v18
    v_exp_f32 v19, v19
    v_exp_f32 v20, v20
    v_exp_f32 v21, v21
    v_mfma_f32_32x32x16_bf16 v[32:47], v[92:95], v[12:15], 0
    s_add_u32 s87, s85, 8192
    buffer_load_dwordx4 v[144:147], v2, s[28:31], s87 offen sc1
    v_exp_f32 v22, v22
    v_exp_f32 v23, v23
    v_cvt_pk_bf16_f32 v48, v16, v17
    v_cvt_pk_bf16_f32 v49, v18, v19
    v_cvt_pk_bf16_f32 v50, v20, v21
    v_cvt_pk_bf16_f32 v51, v22, v23
    v_exp_f32 v24, v24
    v_exp_f32 v25, v25
    v_mfma_f32_32x32x16_bf16 v[56:71], v[112:115], v[48:51], v[56:71]
    buffer_load_dwordx4 v[88:91], v2, s[36:39], s59 offen sc1
    v_exp_f32 v26, v26
    v_exp_f32 v27, v27
    v_exp_f32 v28, v28
    v_exp_f32 v29, v29
    v_exp_f32 v30, v30
    v_exp_f32 v31, v31
    v_cvt_pk_bf16_f32 v52, v24, v25
    v_cvt_pk_bf16_f32 v53, v26, v27
    v_cvt_pk_bf16_f32 v54, v28, v29
    v_cvt_pk_bf16_f32 v55, v30, v31
    v_exp_f32 v32, v32
    v_exp_f32 v33, v33
    v_mfma_f32_32x32x16_bf16 v[56:71], v[116:119], v[52:55], v[56:71]
    s_waitcnt vmcnt(10)
    v_exp_f32 v34, v34
    v_exp_f32 v35, v35
    v_exp_f32 v36, v36
    v_exp_f32 v37, v37
    v_mfma_f32_32x32x16_bf16 v[16:31], v[96:99], v[8:11], 0
    s_xor_b32 s59, s58, 17408
    v_exp_f32 v38, v38
    v_exp_f32 v39, v39
    v_cvt_pk_bf16_f32 v48, v32, v33
    v_cvt_pk_bf16_f32 v49, v34, v35
    v_cvt_pk_bf16_f32 v50, v36, v37
    v_cvt_pk_bf16_f32 v51, v38, v39
    v_exp_f32 v40, v40
    v_exp_f32 v41, v41
    v_mfma_f32_32x32x16_bf16 v[72:87], v[112:115], v[48:51], v[72:87]
    s_add_u32 m0, s86, 24576
    s_mov_b32 s87, 196608
    buffer_load_dwordx4 v241, s[16:19], s87 offen lds
    v_exp_f32 v42, v42
    v_exp_f32 v43, v43
    v_exp_f32 v44, v44
    v_exp_f32 v45, v45
    v_exp_f32 v46, v46
    v_exp_f32 v47, v47
    v_cvt_pk_bf16_f32 v52, v40, v41
    v_cvt_pk_bf16_f32 v53, v42, v43
    v_cvt_pk_bf16_f32 v54, v44, v45
    v_cvt_pk_bf16_f32 v55, v46, v47
    v_exp_f32 v16, v16
    v_exp_f32 v17, v17
    v_mfma_f32_32x32x16_bf16 v[72:87], v[116:119], v[52:55], v[72:87]
    s_mov_b64 exec, s[52:53]
    buffer_load_dwordx4 v[112:115], v6, s[40:43], s59 offen sc1
    buffer_load_dwordx4 v[116:119], v6, s[40:43], s59 offen offset:512 sc1
    s_mov_b64 exec, -1
    v_exp_f32 v18, v18
    v_exp_f32 v19, v19
    v_exp_f32 v20, v20
    v_exp_f32 v21, v21
    v_mfma_f32_32x32x16_bf16 v[32:47], v[96:99], v[12:15], 0
    s_add_u32 s87, s85, 12288
    buffer_load_dwordx4 v[148:151], v2, s[28:31], s87 offen sc1
    v_exp_f32 v22, v22
    v_exp_f32 v23, v23
    v_cvt_pk_bf16_f32 v48, v16, v17
    v_cvt_pk_bf16_f32 v49, v18, v19
    v_cvt_pk_bf16_f32 v50, v20, v21
    v_cvt_pk_bf16_f32 v51, v22, v23
    v_exp_f32 v24, v24
    v_exp_f32 v25, v25
    v_mfma_f32_32x32x16_bf16 v[56:71], v[120:123], v[48:51], v[56:71]
    buffer_load_dwordx4 v[92:95], v2, s[36:39], s59 offen sc1
    v_exp_f32 v26, v26
    v_exp_f32 v27, v27
    v_exp_f32 v28, v28
    v_exp_f32 v29, v29
    v_exp_f32 v30, v30
    v_exp_f32 v31, v31
    v_cvt_pk_bf16_f32 v52, v24, v25
    v_cvt_pk_bf16_f32 v53, v26, v27
    v_cvt_pk_bf16_f32 v54, v28, v29
    v_cvt_pk_bf16_f32 v55, v30, v31
    v_exp_f32 v32, v32
    v_exp_f32 v33, v33
    v_mfma_f32_32x32x16_bf16 v[56:71], v[124:127], v[52:55], v[56:71]
    s_waitcnt vmcnt(10)
    v_exp_f32 v34, v34
    v_exp_f32 v35, v35
    v_exp_f32 v36, v36
    v_exp_f32 v37, v37
    v_mfma_f32_32x32x16_bf16 v[16:31], v[100:103], v[8:11], 0
    s_xor_b32 s59, s58, 18432
    v_exp_f32 v38, v38
    v_exp_f32 v39, v39
    v_cvt_pk_bf16_f32 v48, v32, v33
    v_cvt_pk_bf16_f32 v49, v34, v35
    v_cvt_pk_bf16_f32 v50, v36, v37
    v_cvt_pk_bf16_f32 v51, v38, v39
    v_exp_f32 v40, v40
    v_exp_f32 v41, v41
    v_mfma_f32_32x32x16_bf16 v[72:87], v[120:123], v[48:51], v[72:87]
    s_add_u32 m0, s86, 32768
    s_mov_b32 s87, 262144
    buffer_load_dwordx4 v241, s[16:19], s87 offen lds
    v_exp_f32 v42, v42
    v_exp_f32 v43, v43
    v_exp_f32 v44, v44
    v_exp_f32 v45, v45
    v_exp_f32 v46, v46
    v_exp_f32 v47, v47
    v_cvt_pk_bf16_f32 v52, v40, v41
    v_cvt_pk_bf16_f32 v53, v42, v43
    v_cvt_pk_bf16_f32 v54, v44, v45
    v_cvt_pk_bf16_f32 v55, v46, v47
    v_exp_f32 v16, v16
    v_exp_f32 v17, v17
    v_mfma_f32_32x32x16_bf16 v[72:87], v[124:127], v[52:55], v[72:87]
    s_mov_b64 exec, s[52:53]
    buffer_load_dwordx4 v[120:123], v6, s[40:43], s59 offen sc1
    buffer_load_dwordx4 v[124:127], v6, s[40:43], s59 offen offset:512 sc1
    s_mov_b64 exec, -1
    v_exp_f32 v18, v18
    v_exp_f32 v19, v19
    v_exp_f32 v20, v20
    v_exp_f32 v21, v21
    v_mfma_f32_32x32x16_bf16 v[32:47], v[100:103], v[12:15], 0
    s_add_u32 s87, s85, 16384
    buffer_load_dwordx4 v[152:155], v2, s[28:31], s87 offen sc1
    v_exp_f32 v22, v22
    v_exp_f32 v23, v23
    v_cvt_pk_bf16_f32 v48, v16, v17
    v_cvt_pk_bf16_f32 v49, v18, v19
    v_cvt_pk_bf16_f32 v50, v20, v21
    v_cvt_pk_bf16_f32 v51, v22, v23
    v_exp_f32 v24, v24
    v_exp_f32 v25, v25
    v_mfma_f32_32x32x16_bf16 v[56:71], v[128:131], v[48:51], v[56:71]
    buffer_load_dwordx4 v[96:99], v2, s[36:39], s59 offen sc1
    v_exp_f32 v26, v26
    v_exp_f32 v27, v27
    v_exp_f32 v28, v28
    v_exp_f32 v29, v29
    v_exp_f32 v30, v30
    v_exp_f32 v31, v31
    v_cvt_pk_bf16_f32 v52, v24, v25
    v_cvt_pk_bf16_f32 v53, v26, v27
    v_cvt_pk_bf16_f32 v54, v28, v29
    v_cvt_pk_bf16_f32 v55, v30, v31
    v_exp_f32 v32, v32
    v_exp_f32 v33, v33
    v_mfma_f32_32x32x16_bf16 v[56:71], v[132:135], v[52:55], v[56:71]
    s_waitcnt vmcnt(10)
    v_exp_f32 v34, v34
    v_exp_f32 v35, v35
    v_exp_f32 v36, v36
    v_exp_f32 v37, v37
    v_mfma_f32_32x32x16_bf16 v[16:31], v[88:91], v[8:11], 0
    s_xor_b32 s59, s58, 19456
    v_exp_f32 v38, v38
    v_exp_f32 v39, v39
    v_cvt_pk_bf16_f32 v48, v32, v33
    v_cvt_pk_bf16_f32 v49, v34, v35
    v_cvt_pk_bf16_f32 v50, v36, v37
    v_cvt_pk_bf16_f32 v51, v38, v39
    v_exp_f32 v40, v40
    v_exp_f32 v41, v41
    v_mfma_f32_32x32x16_bf16 v[72:87], v[128:131], v[48:51], v[72:87]
    s_add_u32 m0, s86, 40960
    s_mov_b32 s87, 327680
    buffer_load_dwordx4 v241, s[16:19], s87 offen lds
    v_exp_f32 v42, v42
    v_exp_f32 v43, v43
    v_exp_f32 v44, v44
    v_exp_f32 v45, v45
    v_exp_f32 v46, v46
    v_exp_f32 v47, v47
    v_cvt_pk_bf16_f32 v52, v40, v41
    v_cvt_pk_bf16_f32 v53, v42, v43
    v_cvt_pk_bf16_f32 v54, v44, v45
    v_cvt_pk_bf16_f32 v55, v46, v47
    v_exp_f32 v16, v16
    v_exp_f32 v17, v17
    v_mfma_f32_32x32x16_bf16 v[72:87], v[132:135], v[52:55], v[72:87]
    s_mov_b64 exec, s[52:53]
    buffer_load_dwordx4 v[128:131], v6, s[40:43], s59 offen sc1
    buffer_load_dwordx4 v[132:135], v6, s[40:43], s59 offen offset:512 sc1
    s_mov_b64 exec, -1
    v_exp_f32 v18, v18
    v_exp_f32 v19, v19
    v_exp_f32 v20, v20
    v_exp_f32 v21, v21
    v_mfma_f32_32x32x16_bf16 v[32:47], v[88:91], v[12:15], 0
    s_add_u32 s87, s85, 20480
    buffer_load_dwordx4 v[156:159], v2, s[28:31], s87 offen sc1
    v_exp_f32 v22, v22
    v_exp_f32 v23, v23
    v_cvt_pk_bf16_f32 v48, v16, v17
    v_cvt_pk_bf16_f32 v49, v18, v19
    v_cvt_pk_bf16_f32 v50, v20, v21
    v_cvt_pk_bf16_f32 v51, v22, v23
    v_exp_f32 v24, v24
    v_exp_f32 v25, v25
    v_mfma_f32_32x32x16_bf16 v[56:71], v[104:107], v[48:51], v[56:71]
    buffer_load_dwordx4 v[100:103], v2, s[36:39], s59 offen sc1
    v_exp_f32 v26, v26
    v_exp_f32 v27, v27
    v_exp_f32 v28, v28
    v_exp_f32 v29, v29
    v_exp_f32 v30, v30
    v_exp_f32 v31, v31
    v_cvt_pk_bf16_f32 v52, v24, v25
    v_cvt_pk_bf16_f32 v53, v26, v27
    v_cvt_pk_bf16_f32 v54, v28, v29
    v_cvt_pk_bf16_f32 v55, v30, v31
    v_exp_f32 v32, v32
    v_exp_f32 v33, v33
    v_mfma_f32_32x32x16_bf16 v[56:71], v[108:111], v[52:55], v[56:71]
    s_waitcnt vmcnt(10)
    v_exp_f32 v34, v34
    v_exp_f32 v35, v35
    v_exp_f32 v36, v36
    v_exp_f32 v37, v37
    v_mfma_f32_32x32x16_bf16 v[16:31], v[92:95], v[8:11], 0
    s_xor_b32 s59, s58, 20480
    v_exp_f32 v38, v38
    v_exp_f32 v39, v39
    v_cvt_pk_bf16_f32 v48, v32, v33
    v_cvt_pk_bf16_f32 v49, v34, v35
    v_cvt_pk_bf16_f32 v50, v36, v37
    v_cvt_pk_bf16_f32 v51, v38, v39
    v_exp_f32 v40, v40
    v_exp_f32 v41, v41
    v_mfma_f32_32x32x16_bf16 v[72:87], v[104:107], v[48:51], v[72:87]
    s_add_u32 m0, s86, 49152
    s_mov_b32 s87, 393216
    buffer_load_dwordx4 v241, s[16:19], s87 offen lds
    v_exp_f32 v42, v42
    v_exp_f32 v43, v43
    v_exp_f32 v44, v44
    v_exp_f32 v45, v45
    v_exp_f32 v46, v46
    v_exp_f32 v47, v47
    v_cvt_pk_bf16_f32 v52, v40, v41
    v_cvt_pk_bf16_f32 v53, v42, v43
    v_cvt_pk_bf16_f32 v54, v44, v45
    v_cvt_pk_bf16_f32 v55, v46, v47
    v_exp_f32 v16, v16
    v_exp_f32 v17, v17
    v_mfma_f32_32x32x16_bf16 v[72:87], v[108:111], v[52:55], v[72:87]
    s_mov_b64 exec, s[52:53]
    buffer_load_dwordx4 v[104:107], v6, s[40:43], s59 offen sc1
    buffer_load_dwordx4 v[108:111], v6, s[40:43], s59 offen offset:512 sc1
    s_mov_b64 exec, -1
    v_exp_f32 v18, v18
    v_exp_f32 v19, v19
    v_exp_f32 v20, v20
    v_exp_f32 v21, v21
    v_mfma_f32_32x32x16_bf16 v[32:47], v[92:95], v[12:15], 0
    s_add_u32 s87, s85, 24576
    buffer_load_dwordx4 v[160:163], v2, s[28:31], s87 offen sc1
    v_exp_f32 v22, v22
    v_exp_f32 v23, v23
    v_cvt_pk_bf16_f32 v48, v16, v17
    v_cvt_pk_bf16_f32 v49, v18, v19
    v_cvt_pk_bf16_f32 v50, v20, v21
    v_cvt_pk_bf16_f32 v51, v22, v23
    v_exp_f32 v24, v24
    v_exp_f32 v25, v25
    v_mfma_f32_32x32x16_bf16 v[56:71], v[112:115], v[48:51], v[56:71]
    buffer_load_dwordx4 v[88:91], v2, s[36:39], s59 offen sc1
    v_exp_f32 v26, v26
    v_exp_f32 v27, v27
    v_exp_f32 v28, v28
    v_exp_f32 v29, v29
    v_exp_f32 v30, v30
    v_exp_f32 v31, v31
    v_cvt_pk_bf16_f32 v52, v24, v25
    v_cvt_pk_bf16_f32 v53, v26, v27
    v_cvt_pk_bf16_f32 v54, v28, v29
    v_cvt_pk_bf16_f32 v55, v30, v31
    v_exp_f32 v32, v32
    v_exp_f32 v33, v33
    v_mfma_f32_32x32x16_bf16 v[56:71], v[116:119], v[52:55], v[56:71]
    s_waitcnt vmcnt(10)
    v_exp_f32 v34, v34
    v_exp_f32 v35, v35
    v_exp_f32 v36, v36
    v_exp_f32 v37, v37
    v_mfma_f32_32x32x16_bf16 v[16:31], v[96:99], v[8:11], 0
    s_xor_b32 s59, s58, 21504
    v_exp_f32 v38, v38
    v_exp_f32 v39, v39
    v_cvt_pk_bf16_f32 v48, v32, v33
    v_cvt_pk_bf16_f32 v49, v34, v35
    v_cvt_pk_bf16_f32 v50, v36, v37
    v_cvt_pk_bf16_f32 v51, v38, v39
    v_exp_f32 v40, v40
    v_exp_f32 v41, v41
    v_mfma_f32_32x32x16_bf16 v[72:87], v[112:115], v[48:51], v[72:87]
    s_add_u32 m0, s86, 57344
    s_mov_b32 s87, 458752
    buffer_load_dwordx4 v241, s[16:19], s87 offen lds
    v_exp_f32 v42, v42
    v_exp_f32 v43, v43
    v_exp_f32 v44, v44
    v_exp_f32 v45, v45
    v_exp_f32 v46, v46
    v_exp_f32 v47, v47
    v_cvt_pk_bf16_f32 v52, v40, v41
    v_cvt_pk_bf16_f32 v53, v42, v43
    v_cvt_pk_bf16_f32 v54, v44, v45
    v_cvt_pk_bf16_f32 v55, v46, v47
    v_exp_f32 v16, v16
    v_exp_f32 v17, v17
    v_mfma_f32_32x32x16_bf16 v[72:87], v[116:119], v[52:55], v[72:87]
    s_mov_b64 exec, s[52:53]
    buffer_load_dwordx4 v[112:115], v6, s[40:43], s59 offen sc1
    buffer_load_dwordx4 v[116:119], v6, s[40:43], s59 offen offset:512 sc1
    s_mov_b64 exec, -1
    v_exp_f32 v18, v18
    v_exp_f32 v19, v19
    v_exp_f32 v20, v20
    v_exp_f32 v21, v21
    v_mfma_f32_32x32x16_bf16 v[32:47], v[96:99], v[12:15], 0
    s_add_u32 s87, s85, 28672
    buffer_load_dwordx4 v[164:167], v2, s[28:31], s87 offen sc1
    v_exp_f32 v22, v22
    v_exp_f32 v23, v23
    v_cvt_pk_bf16_f32 v48, v16, v17
    v_cvt_pk_bf16_f32 v49, v18, v19
    v_cvt_pk_bf16_f32 v50, v20, v21
    v_cvt_pk_bf16_f32 v51, v22, v23
    v_exp_f32 v24, v24
    v_exp_f32 v25, v25
    v_mfma_f32_32x32x16_bf16 v[56:71], v[120:123], v[48:51], v[56:71]
    buffer_load_dwordx4 v[92:95], v2, s[36:39], s59 offen sc1
    v_exp_f32 v26, v26
    v_exp_f32 v27, v27
    v_exp_f32 v28, v28
    v_exp_f32 v29, v29
    v_exp_f32 v30, v30
    v_exp_f32 v31, v31
    v_cvt_pk_bf16_f32 v52, v24, v25
    v_cvt_pk_bf16_f32 v53, v26, v27
    v_cvt_pk_bf16_f32 v54, v28, v29
    v_cvt_pk_bf16_f32 v55, v30, v31
    v_exp_f32 v32, v32
    v_exp_f32 v33, v33
    v_mfma_f32_32x32x16_bf16 v[56:71], v[124:127], v[52:55], v[56:71]
    s_waitcnt vmcnt(10)
    v_exp_f32 v34, v34
    v_exp_f32 v35, v35
    v_exp_f32 v36, v36
    v_exp_f32 v37, v37
    v_mfma_f32_32x32x16_bf16 v[16:31], v[100:103], v[8:11], 0
    s_xor_b32 s59, s58, 22528
    v_exp_f32 v38, v38
    v_exp_f32 v39, v39
    v_cvt_pk_bf16_f32 v48, v32, v33
    v_cvt_pk_bf16_f32 v49, v34, v35
    v_cvt_pk_bf16_f32 v50, v36, v37
    v_cvt_pk_bf16_f32 v51, v38, v39
    v_exp_f32 v40, v40
    v_exp_f32 v41, v41
    v_mfma_f32_32x32x16_bf16 v[72:87], v[120:123], v[48:51], v[72:87]
    s_add_u32 m0, s86, 65536
    s_mov_b32 s87, 524288
    buffer_load_dwordx4 v241, s[16:19], s87 offen lds
    v_exp_f32 v42, v42
    v_exp_f32 v43, v43
    v_exp_f32 v44, v44
    v_exp_f32 v45, v45
    v_exp_f32 v46, v46
    v_exp_f32 v47, v47
    v_cvt_pk_bf16_f32 v52, v40, v41
    v_cvt_pk_bf16_f32 v53, v42, v43
    v_cvt_pk_bf16_f32 v54, v44, v45
    v_cvt_pk_bf16_f32 v55, v46, v47
    v_exp_f32 v16, v16
    v_exp_f32 v17, v17
    v_mfma_f32_32x32x16_bf16 v[72:87], v[124:127], v[52:55], v[72:87]
    s_mov_b64 exec, s[52:53]
    buffer_load_dwordx4 v[120:123], v6, s[40:43], s59 offen sc1
    buffer_load_dwordx4 v[124:127], v6, s[40:43], s59 offen offset:512 sc1
    s_mov_b64 exec, -1
    v_exp_f32 v18, v18
    v_exp_f32 v19, v19
    v_exp_f32 v20, v20
    v_exp_f32 v21, v21
    v_mfma_f32_32x32x16_bf16 v[32:47], v[100:103], v[12:15], 0
    s_add_u32 s87, s85, 32768
    buffer_load_dwordx4 v[168:171], v2, s[28:31], s87 offen sc1
    v_exp_f32 v22, v22
    v_exp_f32 v23, v23
    v_cvt_pk_bf16_f32 v48, v16, v17
    v_cvt_pk_bf16_f32 v49, v18, v19
    v_cvt_pk_bf16_f32 v50, v20, v21
    v_cvt_pk_bf16_f32 v51, v22, v23
    v_exp_f32 v24, v24
    v_exp_f32 v25, v25
    v_mfma_f32_32x32x16_bf16 v[56:71], v[128:131], v[48:51], v[56:71]
    buffer_load_dwordx4 v[96:99], v2, s[36:39], s59 offen sc1
    v_exp_f32 v26, v26
    v_exp_f32 v27, v27
    v_exp_f32 v28, v28
    v_exp_f32 v29, v29
    v_exp_f32 v30, v30
    v_exp_f32 v31, v31
    v_cvt_pk_bf16_f32 v52, v24, v25
    v_cvt_pk_bf16_f32 v53, v26, v27
    v_cvt_pk_bf16_f32 v54, v28, v29
    v_cvt_pk_bf16_f32 v55, v30, v31
    v_exp_f32 v32, v32
    v_exp_f32 v33, v33
    v_mfma_f32_32x32x16_bf16 v[56:71], v[132:135], v[52:55], v[56:71]
    s_waitcnt vmcnt(10)
    v_exp_f32 v34, v34
    v_exp_f32 v35, v35
    v_exp_f32 v36, v36
    v_exp_f32 v37, v37
    v_mfma_f32_32x32x16_bf16 v[16:31], v[88:91], v[8:11], 0
    s_xor_b32 s59, s58, 23552
    v_exp_f32 v38, v38
    v_exp_f32 v39, v39
    v_cvt_pk_bf16_f32 v48, v32, v33
    v_cvt_pk_bf16_f32 v49, v34, v35
    v_cvt_pk_bf16_f32 v50, v36, v37
    v_cvt_pk_bf16_f32 v51, v38, v39
    v_exp_f32 v40, v40
    v_exp_f32 v41, v41
    v_mfma_f32_32x32x16_bf16 v[72:87], v[128:131], v[48:51], v[72:87]
    s_add_u32 m0, s86, 73728
    s_mov_b32 s87, 589824
    buffer_load_dwordx4 v241, s[16:19], s87 offen lds
    v_exp_f32 v42, v42
    v_exp_f32 v43, v43
    v_exp_f32 v44, v44
    v_exp_f32 v45, v45
    v_exp_f32 v46, v46
    v_exp_f32 v47, v47
    v_cvt_pk_bf16_f32 v52, v40, v41
    v_cvt_pk_bf16_f32 v53, v42, v43
    v_cvt_pk_bf16_f32 v54, v44, v45
    v_cvt_pk_bf16_f32 v55, v46, v47
    v_exp_f32 v16, v16
    v_exp_f32 v17, v17
    v_mfma_f32_32x32x16_bf16 v[72:87], v[132:135], v[52:55], v[72:87]
    s_mov_b64 exec, s[52:53]
    buffer_load_dwordx4 v[128:131], v6, s[40:43], s59 offen sc1
    buffer_load_dwordx4 v[132:135], v6, s[40:43], s59 offen offset:512 sc1
    s_mov_b64 exec, -1
    v_exp_f32 v18, v18
    v_exp_f32 v19, v19
    v_exp_f32 v20, v20
    v_exp_f32 v21, v21
    v_mfma_f32_32x32x16_bf16 v[32:47], v[88:91], v[12:15], 0
    s_add_u32 s87, s85, 36864
    buffer_load_dwordx4 v[172:175], v2, s[28:31], s87 offen sc1
    s_lshr_b32 s48, s2, 3
    s_lshl_b32 s48, s48, 3
    s_add_u32 s48, s48, s46
    v_lshlrev_b32 v5, 7, v1
    s_mul_i32 s49, s48, 1152
    s_add_u32 s49, s49, 1114112
    s_mov_b64 exec, 511
    buffer_load_dword v250, v5, s[16:19], s49 offen
    s_mov_b64 exec, -1
    s_lshl_b32 s49, s48, 11
    s_mov_b64 exec, 65535
    buffer_load_dword v250, v5, s[20:23], s49 offen
    s_mov_b64 exec, -1
    v_exp_f32 v22, v22
    v_exp_f32 v23, v23
    v_cvt_pk_bf16_f32 v48, v16, v17
    v_cvt_pk_bf16_f32 v49, v18, v19
    v_cvt_pk_bf16_f32 v50, v20, v21
    v_cvt_pk_bf16_f32 v51, v22, v23
    v_exp_f32 v24, v24
    v_exp_f32 v25, v25
    v_mfma_f32_32x32x16_bf16 v[56:71], v[104:107], v[48:51], v[56:71]
    buffer_load_dwordx4 v[100:103], v2, s[36:39], s59 offen sc1
    v_exp_f32 v26, v26
    v_exp_f32 v27, v27
    v_exp_f32 v28, v28
    v_exp_f32 v29, v29
    v_exp_f32 v30, v30
    v_exp_f32 v31, v31
    v_cvt_pk_bf16_f32 v52, v24, v25
    v_cvt_pk_bf16_f32 v53, v26, v27
    v_cvt_pk_bf16_f32 v54, v28, v29
    v_cvt_pk_bf16_f32 v55, v30, v31
    v_exp_f32 v32, v32
    v_exp_f32 v33, v33
    v_mfma_f32_32x32x16_bf16 v[56:71], v[108:111], v[52:55], v[56:71]
    s_waitcnt vmcnt(12)
    v_exp_f32 v34, v34
    v_exp_f32 v35, v35
    v_exp_f32 v36, v36
    v_exp_f32 v37, v37
    v_mfma_f32_32x32x16_bf16 v[16:31], v[92:95], v[8:11], 0
    s_xor_b32 s59, s58, 24576
    v_exp_f32 v38, v38
    v_exp_f32 v39, v39
    v_cvt_pk_bf16_f32 v48, v32, v33
    v_cvt_pk_bf16_f32 v49, v34, v35
    v_cvt_pk_bf16_f32 v50, v36, v37
    v_cvt_pk_bf16_f32 v51, v38, v39
    v_exp_f32 v40, v40
    v_exp_f32 v41, v41
    v_mfma_f32_32x32x16_bf16 v[72:87], v[104:107], v[48:51], v[72:87]
    s_add_u32 m0, s86, 81920
    s_mov_b32 s87, 655360
    buffer_load_dwordx4 v241, s[16:19], s87 offen lds
    v_exp_f32 v42, v42
    v_exp_f32 v43, v43
    v_exp_f32 v44, v44
    v_exp_f32 v45, v45
    v_exp_f32 v46, v46
    v_exp_f32 v47, v47
    v_cvt_pk_bf16_f32 v52, v40, v41
    v_cvt_pk_bf16_f32 v53, v42, v43
    v_cvt_pk_bf16_f32 v54, v44, v45
    v_cvt_pk_bf16_f32 v55, v46, v47
    v_exp_f32 v16, v16
    v_exp_f32 v17, v17
    v_mfma_f32_32x32x16_bf16 v[72:87], v[108:111], v[52:55], v[72:87]
    s_mov_b64 exec, s[52:53]
    buffer_load_dwordx4 v[104:107], v6, s[40:43], s59 offen sc1
    buffer_load_dwordx4 v[108:111], v6, s[40:43], s59 offen offset:512 sc1
    s_mov_b64 exec, -1
    v_exp_f32 v18, v18
    v_exp_f32 v19, v19
    v_exp_f32 v20, v20
    v_exp_f32 v21, v21
    v_mfma_f32_32x32x16_bf16 v[32:47], v[92:95], v[12:15], 0
    s_add_u32 s87, s85, 40960
    buffer_load_dwordx4 v[176:179], v2, s[28:31], s87 offen sc1
    v_exp_f32 v22, v22
    v_exp_f32 v23, v23
    v_cvt_pk_bf16_f32 v48, v16, v17
    v_cvt_pk_bf16_f32 v49, v18, v19
    v_cvt_pk_bf16_f32 v50, v20, v21
    v_cvt_pk_bf16_f32 v51, v22, v23
    v_exp_f32 v24, v24
    v_exp_f32 v25, v25
    v_mfma_f32_32x32x16_bf16 v[56:71], v[112:115], v[48:51], v[56:71]
    buffer_load_dwordx4 v[88:91], v2, s[36:39], s59 offen sc1
    v_exp_f32 v26, v26
    v_exp_f32 v27, v27
    v_exp_f32 v28, v28
    v_exp_f32 v29, v29
    v_exp_f32 v30, v30
    v_exp_f32 v31, v31
    v_cvt_pk_bf16_f32 v52, v24, v25
    v_cvt_pk_bf16_f32 v53, v26, v27
    v_cvt_pk_bf16_f32 v54, v28, v29
    v_cvt_pk_bf16_f32 v55, v30, v31
    v_exp_f32 v32, v32
    v_exp_f32 v33, v33
    v_mfma_f32_32x32x16_bf16 v[56:71], v[116:119], v[52:55], v[56:71]
    s_waitcnt vmcnt(12)
    v_exp_f32 v34, v34
    v_exp_f32 v35, v35
    v_exp_f32 v36, v36
    v_exp_f32 v37, v37
    v_mfma_f32_32x32x16_bf16 v[16:31], v[96:99], v[8:11], 0
    s_xor_b32 s59, s58, 25600
    v_exp_f32 v38, v38
    v_exp_f32 v39, v39
    v_cvt_pk_bf16_f32 v48, v32, v33
    v_cvt_pk_bf16_f32 v49, v34, v35
    v_cvt_pk_bf16_f32 v50, v36, v37
    v_cvt_pk_bf16_f32 v51, v38, v39
    v_exp_f32 v40, v40
    v_exp_f32 v41, v41
    v_mfma_f32_32x32x16_bf16 v[72:87], v[112:115], v[48:51], v[72:87]
    s_add_u32 m0, s86, 90112
    s_mov_b32 s87, 720896
    buffer_load_dwordx4 v241, s[16:19], s87 offen lds
    v_exp_f32 v42, v42
    v_exp_f32 v43, v43
    v_exp_f32 v44, v44
    v_exp_f32 v45, v45
    v_exp_f32 v46, v46
    v_exp_f32 v47, v47
    v_cvt_pk_bf16_f32 v52, v40, v41
    v_cvt_pk_bf16_f32 v53, v42, v43
    v_cvt_pk_bf16_f32 v54, v44, v45
    v_cvt_pk_bf16_f32 v55, v46, v47
    v_exp_f32 v16, v16
    v_exp_f32 v17, v17
    v_mfma_f32_32x32x16_bf16 v[72:87], v[116:119], v[52:55], v[72:87]
    s_mov_b64 exec, s[52:53]
    buffer_load_dwordx4 v[112:115], v6, s[40:43], s59 offen sc1
    buffer_load_dwordx4 v[116:119], v6, s[40:43], s59 offen offset:512 sc1
    s_mov_b64 exec, -1
    v_exp_f32 v18, v18
    v_exp_f32 v19, v19
    v_exp_f32 v20, v20
    v_exp_f32 v21, v21
    v_mfma_f32_32x32x16_bf16 v[32:47], v[96:99], v[12:15], 0
    s_add_u32 s87, s85, 45056
    buffer_load_dwordx4 v[180:183], v2, s[28:31], s87 offen sc1
    v_exp_f32 v22, v22
    v_exp_f32 v23, v23
    v_cvt_pk_bf16_f32 v48, v16, v17
    v_cvt_pk_bf16_f32 v49, v18, v19
    v_cvt_pk_bf16_f32 v50, v20, v21
    v_cvt_pk_bf16_f32 v51, v22, v23
    v_exp_f32 v24, v24
    v_exp_f32 v25, v25
    v_mfma_f32_32x32x16_bf16 v[56:71], v[120:123], v[48:51], v[56:71]
    buffer_load_dwordx4 v[92:95], v2, s[36:39], s59 offen sc1
    v_exp_f32 v26, v26
    v_exp_f32 v27, v27
    v_exp_f32 v28, v28
    v_exp_f32 v29, v29
    v_exp_f32 v30, v30
    v_exp_f32 v31, v31
    v_cvt_pk_bf16_f32 v52, v24, v25
    v_cvt_pk_bf16_f32 v53, v26, v27
    v_cvt_pk_bf16_f32 v54, v28, v29
    v_cvt_pk_bf16_f32 v55, v30, v31
    v_exp_f32 v32, v32
    v_exp_f32 v33, v33
    v_mfma_f32_32x32x16_bf16 v[56:71], v[124:127], v[52:55], v[56:71]
    s_waitcnt vmcnt(10)
    v_exp_f32 v34, v34
    v_exp_f32 v35, v35
    v_exp_f32 v36, v36
    v_exp_f32 v37, v37
    v_mfma_f32_32x32x16_bf16 v[16:31], v[100:103], v[8:11], 0
    s_xor_b32 s59, s58, 26624
    v_exp_f32 v38, v38
    v_exp_f32 v39, v39
    v_cvt_pk_bf16_f32 v48, v32, v33
    v_cvt_pk_bf16_f32 v49, v34, v35
    v_cvt_pk_bf16_f32 v50, v36, v37
    v_cvt_pk_bf16_f32 v51, v38, v39
    v_exp_f32 v40, v40
    v_exp_f32 v41, v41
    v_mfma_f32_32x32x16_bf16 v[72:87], v[120:123], v[48:51], v[72:87]
    s_add_u32 m0, s86, 98304
    s_mov_b32 s87, 786432
    buffer_load_dwordx4 v241, s[16:19], s87 offen lds
    v_exp_f32 v42, v42
    v_exp_f32 v43, v43
    v_exp_f32 v44, v44
    v_exp_f32 v45, v45
    v_exp_f32 v46, v46
    v_exp_f32 v47, v47
    v_cvt_pk_bf16_f32 v52, v40, v41
    v_cvt_pk_bf16_f32 v53, v42, v43
    v_cvt_pk_bf16_f32 v54, v44, v45
    v_cvt_pk_bf16_f32 v55, v46, v47
    v_exp_f32 v16, v16
    v_exp_f32 v17, v17
    v_mfma_f32_32x32x16_bf16 v[72:87], v[124:127], v[52:55], v[72:87]
    s_mov_b64 exec, s[52:53]
    buffer_load_dwordx4 v[120:123], v6, s[40:43], s59 offen sc1
    buffer_load_dwordx4 v[124:127], v6, s[40:43], s59 offen offset:512 sc1
    s_mov_b64 exec, -1
    v_exp_f32 v18, v18
    v_exp_f32 v19, v19
    v_exp_f32 v20, v20
    v_exp_f32 v21, v21
    v_mfma_f32_32x32x16_bf16 v[32:47], v[100:103], v[12:15], 0
    s_add_u32 s87, s85, 49152
    buffer_load_dwordx4 v[184:187], v2, s[28:31], s87 offen sc1
    v_exp_f32 v22, v22
    v_exp_f32 v23, v23
    v_cvt_pk_bf16_f32 v48, v16, v17
    v_cvt_pk_bf16_f32 v49, v18, v19
    v_cvt_pk_bf16_f32 v50, v20, v21
    v_cvt_pk_bf16_f32 v51, v22, v23
    v_exp_f32 v24, v24
    v_exp_f32 v25, v25
    v_mfma_f32_32x32x16_bf16 v[56:71], v[128:131], v[48:51], v[56:71]
    buffer_load_dwordx4 v[96:99], v2, s[36:39], s59 offen sc1
    v_exp_f32 v26, v26
    v_exp_f32 v27, v27
    v_exp_f32 v28, v28
    v_exp_f32 v29, v29
    v_exp_f32 v30, v30
    v_exp_f32 v31, v31
    v_cvt_pk_bf16_f32 v52, v24, v25
    v_cvt_pk_bf16_f32 v53, v26, v27
    v_cvt_pk_bf16_f32 v54, v28, v29
    v_cvt_pk_bf16_f32 v55, v30, v31
    v_exp_f32 v32, v32
    v_exp_f32 v33, v33
    v_mfma_f32_32x32x16_bf16 v[56:71], v[132:135], v[52:55], v[56:71]
    s_waitcnt vmcnt(10)
    v_exp_f32 v34, v34
    v_exp_f32 v35, v35
    v_exp_f32 v36, v36
    v_exp_f32 v37, v37
    v_mfma_f32_32x32x16_bf16 v[16:31], v[88:91], v[8:11], 0
    s_xor_b32 s59, s58, 27648
    v_exp_f32 v38, v38
    v_exp_f32 v39, v39
    v_cvt_pk_bf16_f32 v48, v32, v33
    v_cvt_pk_bf16_f32 v49, v34, v35
    v_cvt_pk_bf16_f32 v50, v36, v37
    v_cvt_pk_bf16_f32 v51, v38, v39
    v_exp_f32 v40, v40
    v_exp_f32 v41, v41
    v_mfma_f32_32x32x16_bf16 v[72:87], v[128:131], v[48:51], v[72:87]
    s_add_u32 m0, s86, 106496
    s_mov_b32 s87, 851968
    buffer_load_dwordx4 v241, s[16:19], s87 offen lds
    v_exp_f32 v42, v42
    v_exp_f32 v43, v43
    v_exp_f32 v44, v44
    v_exp_f32 v45, v45
    v_exp_f32 v46, v46
    v_exp_f32 v47, v47
    v_cvt_pk_bf16_f32 v52, v40, v41
    v_cvt_pk_bf16_f32 v53, v42, v43
    v_cvt_pk_bf16_f32 v54, v44, v45
    v_cvt_pk_bf16_f32 v55, v46, v47
    v_exp_f32 v16, v16
    v_exp_f32 v17, v17
    v_mfma_f32_32x32x16_bf16 v[72:87], v[132:135], v[52:55], v[72:87]
    s_mov_b64 exec, s[52:53]
    buffer_load_dwordx4 v[128:131], v6, s[40:43], s59 offen sc1
    buffer_load_dwordx4 v[132:135], v6, s[40:43], s59 offen offset:512 sc1
    s_mov_b64 exec, -1
    v_exp_f32 v18, v18
    v_exp_f32 v19, v19
    v_exp_f32 v20, v20
    v_exp_f32 v21, v21
    v_mfma_f32_32x32x16_bf16 v[32:47], v[88:91], v[12:15], 0
    s_add_u32 s87, s85, 53248
    buffer_load_dwordx4 v[188:191], v2, s[28:31], s87 offen sc1
    v_exp_f32 v22, v22
    v_exp_f32 v23, v23
    v_cvt_pk_bf16_f32 v48, v16, v17
    v_cvt_pk_bf16_f32 v49, v18, v19
    v_cvt_pk_bf16_f32 v50, v20, v21
    v_cvt_pk_bf16_f32 v51, v22, v23
    v_exp_f32 v24, v24
    v_exp_f32 v25, v25
    v_mfma_f32_32x32x16_bf16 v[56:71], v[104:107], v[48:51], v[56:71]
    buffer_load_dwordx4 v[100:103], v2, s[36:39], s59 offen sc1
    v_exp_f32 v26, v26
    v_exp_f32 v27, v27
    v_exp_f32 v28, v28
    v_exp_f32 v29, v29
    v_exp_f32 v30, v30
    v_exp_f32 v31, v31
    v_cvt_pk_bf16_f32 v52, v24, v25
    v_cvt_pk_bf16_f32 v53, v26, v27
    v_cvt_pk_bf16_f32 v54, v28, v29
    v_cvt_pk_bf16_f32 v55, v30, v31
    v_exp_f32 v32, v32
    v_exp_f32 v33, v33
    v_mfma_f32_32x32x16_bf16 v[56:71], v[108:111], v[52:55], v[56:71]
    s_waitcnt vmcnt(10)
    v_exp_f32 v34, v34
    v_exp_f32 v35, v35
    v_exp_f32 v36, v36
    v_exp_f32 v37, v37
    v_mfma_f32_32x32x16_bf16 v[16:31], v[92:95], v[8:11], 0
    s_xor_b32 s59, s58, 28672
    v_exp_f32 v38, v38
    v_exp_f32 v39, v39
    v_cvt_pk_bf16_f32 v48, v32, v33
    v_cvt_pk_bf16_f32 v49, v34, v35
    v_cvt_pk_bf16_f32 v50, v36, v37
    v_cvt_pk_bf16_f32 v51, v38, v39
    v_exp_f32 v40, v40
    v_exp_f32 v41, v41
    v_mfma_f32_32x32x16_bf16 v[72:87], v[104:107], v[48:51], v[72:87]
    s_add_u32 m0, s86, 114688
    s_mov_b32 s87, 917504
    buffer_load_dwordx4 v241, s[16:19], s87 offen lds
    v_exp_f32 v42, v42
    v_exp_f32 v43, v43
    v_exp_f32 v44, v44
    v_exp_f32 v45, v45
    v_exp_f32 v46, v46
    v_exp_f32 v47, v47
    v_cvt_pk_bf16_f32 v52, v40, v41
    v_cvt_pk_bf16_f32 v53, v42, v43
    v_cvt_pk_bf16_f32 v54, v44, v45
    v_cvt_pk_bf16_f32 v55, v46, v47
    v_exp_f32 v16, v16
    v_exp_f32 v17, v17
    v_mfma_f32_32x32x16_bf16 v[72:87], v[108:111], v[52:55], v[72:87]
    s_mov_b64 exec, s[52:53]
    buffer_load_dwordx4 v[104:107], v6, s[40:43], s59 offen sc1
    buffer_load_dwordx4 v[108:111], v6, s[40:43], s59 offen offset:512 sc1
    s_mov_b64 exec, -1
    v_exp_f32 v18, v18
    v_exp_f32 v19, v19
    v_exp_f32 v20, v20
    v_exp_f32 v21, v21
    v_mfma_f32_32x32x16_bf16 v[32:47], v[92:95], v[12:15], 0
    s_add_u32 s87, s85, 57344
    buffer_load_dwordx4 v[192:195], v2, s[28:31], s87 offen sc1
    v_exp_f32 v22, v22
    v_exp_f32 v23, v23
    v_cvt_pk_bf16_f32 v48, v16, v17
    v_cvt_pk_bf16_f32 v49, v18, v19
    v_cvt_pk_bf16_f32 v50, v20, v21
    v_cvt_pk_bf16_f32 v51, v22, v23
    v_exp_f32 v24, v24
    v_exp_f32 v25, v25
    v_mfma_f32_32x32x16_bf16 v[56:71], v[112:115], v[48:51], v[56:71]
    buffer_load_dwordx4 v[88:91], v2, s[36:39], s59 offen sc1
    v_exp_f32 v26, v26
    v_exp_f32 v27, v27
    v_exp_f32 v28, v28
    v_exp_f32 v29, v29
    v_exp_f32 v30, v30
    v_exp_f32 v31, v31
    v_cvt_pk_bf16_f32 v52, v24, v25
    v_cvt_pk_bf16_f32 v53, v26, v27
    v_cvt_pk_bf16_f32 v54, v28, v29
    v_cvt_pk_bf16_f32 v55, v30, v31
    v_exp_f32 v32, v32
    v_exp_f32 v33, v33
    v_mfma_f32_32x32x16_bf16 v[56:71], v[116:119], v[52:55], v[56:71]
    s_waitcnt vmcnt(10)
    v_exp_f32 v34, v34
    v_exp_f32 v35, v35
    v_exp_f32 v36, v36
    v_exp_f32 v37, v37
    v_mfma_f32_32x32x16_bf16 v[16:31], v[96:99], v[8:11], 0
    s_xor_b32 s59, s58, 29696
    v_exp_f32 v38, v38
    v_exp_f32 v39, v39
    v_cvt_pk_bf16_f32 v48, v32, v33
    v_cvt_pk_bf16_f32 v49, v34, v35
    v_cvt_pk_bf16_f32 v50, v36, v37
    v_cvt_pk_bf16_f32 v51, v38, v39
    v_exp_f32 v40, v40
    v_exp_f32 v41, v41
    v_mfma_f32_32x32x16_bf16 v[72:87], v[112:115], v[48:51], v[72:87]
    s_add_u32 m0, s86, 122880
    s_mov_b32 s87, 983040
    buffer_load_dwordx4 v241, s[16:19], s87 offen lds
    v_exp_f32 v42, v42
    v_exp_f32 v43, v43
    v_exp_f32 v44, v44
    v_exp_f32 v45, v45
    v_exp_f32 v46, v46
    v_exp_f32 v47, v47
    v_cvt_pk_bf16_f32 v52, v40, v41
    v_cvt_pk_bf16_f32 v53, v42, v43
    v_cvt_pk_bf16_f32 v54, v44, v45
    v_cvt_pk_bf16_f32 v55, v46, v47
    v_exp_f32 v16, v16
    v_exp_f32 v17, v17
    v_mfma_f32_32x32x16_bf16 v[72:87], v[116:119], v[52:55], v[72:87]
    s_mov_b64 exec, s[52:53]
    buffer_load_dwordx4 v[112:115], v6, s[40:43], s59 offen sc1
    buffer_load_dwordx4 v[116:119], v6, s[40:43], s59 offen offset:512 sc1
    s_mov_b64 exec, -1
    v_exp_f32 v18, v18
    v_exp_f32 v19, v19
    v_exp_f32 v20, v20
    v_exp_f32 v21, v21
    v_mfma_f32_32x32x16_bf16 v[32:47], v[96:99], v[12:15], 0
    s_add_u32 s87, s85, 61440
    buffer_load_dwordx4 v[196:199], v2, s[28:31], s87 offen sc1
    v_exp_f32 v22, v22
    v_exp_f32 v23, v23
    v_cvt_pk_bf16_f32 v48, v16, v17
    v_cvt_pk_bf16_f32 v49, v18, v19
    v_cvt_pk_bf16_f32 v50, v20, v21
    v_cvt_pk_bf16_f32 v51, v22, v23
    v_exp_f32 v24, v24
    v_exp_f32 v25, v25
    v_mfma_f32_32x32x16_bf16 v[56:71], v[120:123], v[48:51], v[56:71]
    buffer_load_dwordx4 v[92:95], v2, s[36:39], s59 offen sc1
    v_exp_f32 v26, v26
    v_exp_f32 v27, v27
    v_exp_f32 v28, v28
    v_exp_f32 v29, v29
    v_exp_f32 v30, v30
    v_exp_f32 v31, v31
    v_cvt_pk_bf16_f32 v52, v24, v25
    v_cvt_pk_bf16_f32 v53, v26, v27
    v_cvt_pk_bf16_f32 v54, v28, v29
    v_cvt_pk_bf16_f32 v55, v30, v31
    v_exp_f32 v32, v32
    v_exp_f32 v33, v33
    v_mfma_f32_32x32x16_bf16 v[56:71], v[124:127], v[52:55], v[56:71]
    s_waitcnt vmcnt(10)
    v_exp_f32 v34, v34
    v_exp_f32 v35, v35
    v_exp_f32 v36, v36
    v_exp_f32 v37, v37
    v_mfma_f32_32x32x16_bf16 v[16:31], v[100:103], v[8:11], 0
    s_xor_b32 s59, s58, 30720
    v_exp_f32 v38, v38
    v_exp_f32 v39, v39
    v_cvt_pk_bf16_f32 v48, v32, v33
    v_cvt_pk_bf16_f32 v49, v34, v35
    v_cvt_pk_bf16_f32 v50, v36, v37
    v_cvt_pk_bf16_f32 v51, v38, v39
    v_exp_f32 v40, v40
    v_exp_f32 v41, v41
    v_mfma_f32_32x32x16_bf16 v[72:87], v[120:123], v[48:51], v[72:87]
    s_add_u32 m0, s86, 131072
    s_mov_b32 s87, 1048576
    buffer_load_dwordx4 v241, s[16:19], s87 offen lds
    v_exp_f32 v42, v42
    v_exp_f32 v43, v43
    v_exp_f32 v44, v44
    v_exp_f32 v45, v45
    v_exp_f32 v46, v46
    v_exp_f32 v47, v47
    v_cvt_pk_bf16_f32 v52, v40, v41
    v_cvt_pk_bf16_f32 v53, v42, v43
    v_cvt_pk_bf16_f32 v54, v44, v45
    v_cvt_pk_bf16_f32 v55, v46, v47
    v_exp_f32 v16, v16
    v_exp_f32 v17, v17
    v_mfma_f32_32x32x16_bf16 v[72:87], v[124:127], v[52:55], v[72:87]
    s_mov_b64 exec, s[52:53]
    buffer_load_dwordx4 v[120:123], v6, s[40:43], s59 offen sc1
    buffer_load_dwordx4 v[124:127], v6, s[40:43], s59 offen offset:512 sc1
    s_mov_b64 exec, -1
    v_exp_f32 v18, v18
    v_exp_f32 v19, v19
    v_exp_f32 v20, v20
    v_exp_f32 v21, v21
    v_mfma_f32_32x32x16_bf16 v[32:47], v[100:103], v[12:15], 0
    s_add_u32 s87, s85, 65536
    buffer_load_dwordx4 v[200:203], v2, s[28:31], s87 offen sc1
    v_exp_f32 v22, v22
    v_exp_f32 v23, v23
    v_cvt_pk_bf16_f32 v48, v16, v17
    v_cvt_pk_bf16_f32 v49, v18, v19
    v_cvt_pk_bf16_f32 v50, v20, v21
    v_cvt_pk_bf16_f32 v51, v22, v23
    v_exp_f32 v24, v24
    v_exp_f32 v25, v25
    v_mfma_f32_32x32x16_bf16 v[56:71], v[128:131], v[48:51], v[56:71]
    buffer_load_dwordx4 v[96:99], v2, s[36:39], s59 offen sc1
    v_exp_f32 v26, v26
    v_exp_f32 v27, v27
    v_exp_f32 v28, v28
    v_exp_f32 v29, v29
    v_exp_f32 v30, v30
    v_exp_f32 v31, v31
    v_cvt_pk_bf16_f32 v52, v24, v25
    v_cvt_pk_bf16_f32 v53, v26, v27
    v_cvt_pk_bf16_f32 v54, v28, v29
    v_cvt_pk_bf16_f32 v55, v30, v31
    v_exp_f32 v32, v32
    v_exp_f32 v33, v33
    v_mfma_f32_32x32x16_bf16 v[56:71], v[132:135], v[52:55], v[56:71]
    s_waitcnt vmcnt(10)
    v_exp_f32 v34, v34
    v_exp_f32 v35, v35
    v_exp_f32 v36, v36
    v_exp_f32 v37, v37
    v_mfma_f32_32x32x16_bf16 v[16:31], v[88:91], v[8:11], 0
    s_xor_b32 s59, s58, 31744
    v_exp_f32 v38, v38
    v_exp_f32 v39, v39
    v_cvt_pk_bf16_f32 v48, v32, v33
    v_cvt_pk_bf16_f32 v49, v34, v35
    v_cvt_pk_bf16_f32 v50, v36, v37
    v_cvt_pk_bf16_f32 v51, v38, v39
    v_exp_f32 v40, v40
    v_exp_f32 v41, v41
    v_mfma_f32_32x32x16_bf16 v[72:87], v[128:131], v[48:51], v[72:87]
    s_add_u32 s87, s85, 69632
    buffer_load_dwordx4 v[204:207], v2, s[28:31], s87 offen sc1
    v_exp_f32 v42, v42
    v_exp_f32 v43, v43
    v_exp_f32 v44, v44
    v_exp_f32 v45, v45
    v_exp_f32 v46, v46
    v_exp_f32 v47, v47
    v_cvt_pk_bf16_f32 v52, v40, v41
    v_cvt_pk_bf16_f32 v53, v42, v43
    v_cvt_pk_bf16_f32 v54, v44, v45
    v_cvt_pk_bf16_f32 v55, v46, v47
    v_exp_f32 v16, v16
    v_exp_f32 v17, v17
    v_mfma_f32_32x32x16_bf16 v[72:87], v[132:135], v[52:55], v[72:87]
    s_mov_b64 exec, s[52:53]
    buffer_load_dwordx4 v[128:131], v6, s[40:43], s59 offen sc1
    buffer_load_dwordx4 v[132:135], v6, s[40:43], s59 offen offset:512 sc1
    s_mov_b64 exec, -1
    v_exp_f32 v18, v18
    v_exp_f32 v19, v19
    v_exp_f32 v20, v20
    v_exp_f32 v21, v21
    v_mfma_f32_32x32x16_bf16 v[32:47], v[88:91], v[12:15], 0
    s_cmp_ge_u32 s46, 4
    s_cbranch_scc1 L_prio_a
    s_setprio 0
L_prio_a:
    s_add_u32 s87, s85, 73728
    buffer_load_dwordx4 v[208:211], v2, s[28:31], s87 offen sc1
    v_exp_f32 v22, v22
    v_exp_f32 v23, v23
    v_cvt_pk_bf16_f32 v48, v16, v17
    v_cvt_pk_bf16_f32 v49, v18, v19
    v_cvt_pk_bf16_f32 v50, v20, v21
    v_cvt_pk_bf16_f32 v51, v22, v23
    v_exp_f32 v24, v24
    v_exp_f32 v25, v25
    v_mfma_f32_32x32x16_bf16 v[56:71], v[104:107], v[48:51], v[56:71]
    buffer_load_dwordx4 v[100:103], v2, s[36:39], s59 offen sc1
    v_exp_f32 v26, v26
    v_exp_f32 v27, v27
    v_exp_f32 v28, v28
    v_exp_f32 v29, v29
    v_exp_f32 v30, v30
    v_exp_f32 v31, v31
    v_cvt_pk_bf16_f32 v52, v24, v25
    v_cvt_pk_bf16_f32 v53, v26, v27
    v_cvt_pk_bf16_f32 v54, v28, v29
    v_cvt_pk_bf16_f32 v55, v30, v31
    v_exp_f32 v32, v32
    v_exp_f32 v33, v33
    v_mfma_f32_32x32x16_bf16 v[56:71], v[108:111], v[52:55], v[56:71]
    s_waitcnt vmcnt(10)
    v_exp_f32 v34, v34
    v_exp_f32 v35, v35
    v_exp_f32 v36, v36
    v_exp_f32 v37, v37
    v_mfma_f32_32x32x16_bf16 v[16:31], v[92:95], v[8:11], 0
    v_exp_f32 v38, v38
    v_exp_f32 v39, v39
    v_cvt_pk_bf16_f32 v48, v32, v33
    v_cvt_pk_bf16_f32 v49, v34, v35
    v_cvt_pk_bf16_f32 v50, v36, v37
    v_cvt_pk_bf16_f32 v51, v38, v39
    v_exp_f32 v40, v40
    v_exp_f32 v41, v41
    v_mfma_f32_32x32x16_bf16 v[72:87], v[104:107], v[48:51], v[72:87]
    s_add_u32 s87, s85, 77824
    buffer_load_dwordx4 v[212:215], v2, s[28:31], s87 offen sc1
    v_exp_f32 v42, v42
    v_exp_f32 v43, v43
    v_exp_f32 v44, v44
    v_exp_f32 v45, v45
    v_exp_f32 v46, v46
    v_exp_f32 v47, v47
    v_cvt_pk_bf16_f32 v52, v40, v41
    v_cvt_pk_bf16_f32 v53, v42, v43
    v_cvt_pk_bf16_f32 v54, v44, v45
    v_cvt_pk_bf16_f32 v55, v46, v47
    v_exp_f32 v16, v16
    v_exp_f32 v17, v17
    v_mfma_f32_32x32x16_bf16 v[72:87], v[108:111], v[52:55], v[72:87]
    v_exp_f32 v18, v18
    v_exp_f32 v19, v19
    v_exp_f32 v20, v20
    v_exp_f32 v21, v21
    v_mfma_f32_32x32x16_bf16 v[32:47], v[92:95], v[12:15], 0
    s_add_u32 s87, s85, 81920
    buffer_load_dwordx4 v[216:219], v2, s[28:31], s87 offen sc1
    v_exp_f32 v22, v22
    v_exp_f32 v23, v23
    v_cvt_pk_bf16_f32 v48, v16, v17
    v_cvt_pk_bf16_f32 v49, v18, v19
    v_cvt_pk_bf16_f32 v50, v20, v21
    v_cvt_pk_bf16_f32 v51, v22, v23
    v_exp_f32 v24, v24
    v_exp_f32 v25, v25
    v_mfma_f32_32x32x16_bf16 v[56:71], v[112:115], v[48:51], v[56:71]
    v_exp_f32 v26, v26
    v_exp_f32 v27, v27
    v_exp_f32 v28, v28
    v_exp_f32 v29, v29
    v_exp_f32 v30, v30
    v_exp_f32 v31, v31
    v_cvt_pk_bf16_f32 v52, v24, v25
    v_cvt_pk_bf16_f32 v53, v26, v27
    v_cvt_pk_bf16_f32 v54, v28, v29
    v_cvt_pk_bf16_f32 v55, v30, v31
    v_exp_f32 v32, v32
    v_exp_f32 v33, v33
    v_mfma_f32_32x32x16_bf16 v[56:71], v[116:119], v[52:55], v[56:71]
    s_waitcnt vmcnt(7)
    v_exp_f32 v34, v34
    v_exp_f32 v35, v35
    v_exp_f32 v36, v36
    v_exp_f32 v37, v37
    v_mfma_f32_32x32x16_bf16 v[16:31], v[96:99], v[8:11], 0
    v_exp_f32 v38, v38
    v_exp_f32 v39, v39
    v_cvt_pk_bf16_f32 v48, v32, v33
    v_cvt_pk_bf16_f32 v49, v34, v35
    v_cvt_pk_bf16_f32 v50, v36, v37
    v_cvt_pk_bf16_f32 v51, v38, v39
    v_exp_f32 v40, v40
    v_exp_f32 v41, v41
    v_mfma_f32_32x32x16_bf16 v[72:87], v[112:115], v[48:51], v[72:87]
    s_add_u32 s87, s85, 86016
    buffer_load_dwordx4 v[220:223], v2, s[28:31], s87 offen sc1
    v_exp_f32 v42, v42
    v_exp_f32 v43, v43
    v_exp_f32 v44, v44
    v_exp_f32 v45, v45
    v_exp_f32 v46, v46
    v_exp_f32 v47, v47
    v_cvt_pk_bf16_f32 v52, v40, v41
    v_cvt_pk_bf16_f32 v53, v42, v43
    v_cvt_pk_bf16_f32 v54, v44, v45
    v_cvt_pk_bf16_f32 v55, v46, v47
    v_exp_f32 v16, v16
    v_exp_f32 v17, v17
    v_mfma_f32_32x32x16_bf16 v[72:87], v[116:119], v[52:55], v[72:87]
    v_exp_f32 v18, v18
    v_exp_f32 v19, v19
    v_exp_f32 v20, v20
    v_exp_f32 v21, v21
    v_mfma_f32_32x32x16_bf16 v[32:47], v[96:99], v[12:15], 0
    s_lshl_b32 s48, s62, 6
    s_lshl_b32 s49, s57, 5
    s_add_u32 s48, s48, s49
    s_lshl_b32 s48, s48, 2
    s_add_u32 s48, s48, 32768
    v_and_b32 v5, 31, v1
    v_lshlrev_b32 v5, 2, v5
    buffer_load_dword v7, v5, s[28:31], s48 offen sc1
    v_exp_f32 v22, v22
    v_exp_f32 v23, v23
    v_cvt_pk_bf16_f32 v48, v16, v17
    v_cvt_pk_bf16_f32 v49, v18, v19
    v_cvt_pk_bf16_f32 v50, v20, v21
    v_cvt_pk_bf16_f32 v51, v22, v23
    v_exp_f32 v24, v24
    v_exp_f32 v25, v25
    v_mfma_f32_32x32x16_bf16 v[56:71], v[120:123], v[48:51], v[56:71]
    v_exp_f32 v26, v26
    v_exp_f32 v27, v27
    v_exp_f32 v28, v28
    v_exp_f32 v29, v29
    v_exp_f32 v30, v30
    v_exp_f32 v31, v31
    v_cvt_pk_bf16_f32 v52, v24, v25
    v_cvt_pk_bf16_f32 v53, v26, v27
    v_cvt_pk_bf16_f32 v54, v28, v29
    v_cvt_pk_bf16_f32 v55, v30, v31
    v_exp_f32 v32, v32
    v_exp_f32 v33, v33
    v_mfma_f32_32x32x16_bf16 v[56:71], v[124:127], v[52:55], v[56:71]
    s_waitcnt vmcnt(4)
    v_exp_f32 v34, v34
    v_exp_f32 v35, v35
    v_exp_f32 v36, v36
    v_exp_f32 v37, v37
    v_mfma_f32_32x32x16_bf16 v[16:31], v[100:103], v[8:11], 0
    v_exp_f32 v38, v38
    v_exp_f32 v39, v39
    v_cvt_pk_bf16_f32 v48, v32, v33
    v_cvt_pk_bf16_f32 v49, v34, v35
    v_cvt_pk_bf16_f32 v50, v36, v37
    v_cvt_pk_bf16_f32 v51, v38, v39
    v_exp_f32 v40, v40
    v_exp_f32 v41, v41
    v_mfma_f32_32x32x16_bf16 v[72:87], v[120:123], v[48:51], v[72:87]
    v_exp_f32 v42, v42
    v_exp_f32 v43, v43
    v_exp_f32 v44, v44
    v_exp_f32 v45, v45
    v_exp_f32 v46, v46
    v_exp_f32 v47, v47
    v_cvt_pk_bf16_f32 v52, v40, v41
    v_cvt_pk_bf16_f32 v53, v42, v43
    v_cvt_pk_bf16_f32 v54, v44, v45
    v_cvt_pk_bf16_f32 v55, v46, v47
    v_exp_f32 v16, v16
    v_exp_f32 v17, v17
    v_mfma_f32_32x32x16_bf16 v[72:87], v[124:127], v[52:55], v[72:87]
    v_exp_f32 v18, v18
    v_exp_f32 v19, v19
    v_exp_f32 v20, v20
    v_exp_f32 v21, v21
    v_mfma_f32_32x32x16_bf16 v[32:47], v[100:103], v[12:15], 0
    v_exp_f32 v22, v22
    v_exp_f32 v23, v23
    v_cvt_pk_bf16_f32 v48, v16, v17
    v_cvt_pk_bf16_f32 v49, v18, v19
    v_cvt_pk_bf16_f32 v50, v20, v21
    v_cvt_pk_bf16_f32 v51, v22, v23
    v_exp_f32 v24, v24
    v_exp_f32 v25, v25
    v_mfma_f32_32x32x16_bf16 v[56:71], v[128:131], v[48:51], v[56:71]
    v_exp_f32 v26, v26
    v_exp_f32 v27, v27
    v_exp_f32 v28, v28
    v_exp_f32 v29, v29
    v_exp_f32 v30, v30
    v_exp_f32 v31, v31
    v_cvt_pk_bf16_f32 v52, v24, v25
    v_cvt_pk_bf16_f32 v53, v26, v27
    v_cvt_pk_bf16_f32 v54, v28, v29
    v_cvt_pk_bf16_f32 v55, v30, v31
    v_exp_f32 v32, v32
    v_exp_f32 v33, v33
    v_mfma_f32_32x32x16_bf16 v[56:71], v[132:135], v[52:55], v[56:71]
    v_exp_f32 v34, v34
    v_exp_f32 v35, v35
    v_exp_f32 v36, v36
    v_exp_f32 v37, v37
    v_exp_f32 v38, v38
    v_exp_f32 v39, v39
    v_cvt_pk_bf16_f32 v48, v32, v33
    v_cvt_pk_bf16_f32 v49, v34, v35
    v_cvt_pk_bf16_f32 v50, v36, v37
    v_cvt_pk_bf16_f32 v51, v38, v39
    v_exp_f32 v40, v40
    v_exp_f32 v41, v41
    v_mfma_f32_32x32x16_bf16 v[72:87], v[128:131], v[48:51], v[72:87]
    v_exp_f32 v42, v42
    v_exp_f32 v43, v43
    v_exp_f32 v44, v44
    v_exp_f32 v45, v45
    v_exp_f32 v46, v46
    v_exp_f32 v47, v47
    v_cvt_pk_bf16_f32 v52, v40, v41
    v_cvt_pk_bf16_f32 v53, v42, v43
    v_cvt_pk_bf16_f32 v54, v44, v45
    v_cvt_pk_bf16_f32 v55, v46, v47
    s_nop 1
    v_mfma_f32_32x32x16_bf16 v[72:87], v[132:135], v[52:55], v[72:87]
    s_setprio 0
    s_mul_i32 s48, s46, 2304
    s_add_u32 s48, s48, 139264
    v_add_u32 v246, s48, v2
    v_add_u32 v3, s48, v252
    s_xor_b32 s49, s46, 1
    s_mul_i32 s49, s49, 2304
    s_add_u32 s49, s49, 139264
    v_add_u32 v247, s49, v2
    v_add_u32 v4, s49, v252
    s_nop 3
    s_cmp_eq_u32 s57, 0
    s_cbranch_scc1 L_b0
    ds_write_b128 v246, v[56:59]
    ds_write_b128 v246, v[60:63] offset:1024
    ds_write_b32 v3, v64 offset:2048
    s_branch L_bx
L_b0:
    ds_write_b128 v246, v[72:75]
    ds_write_b128 v246, v[76:79] offset:1024
    ds_write_b32 v3, v80 offset:2048
L_bx:
    s_waitcnt vmcnt(0)
    s_waitcnt lgkmcnt(0)
    s_barrier
    ds_read_b128 v[16:19], v247
    ds_read_b128 v[20:23], v247 offset:1024
    ds_read_b32 v24, v4 offset:2048
    s_cmp_eq_u32 s57, 0
    s_waitcnt lgkmcnt(0)
    s_cbranch_scc1 L_c0
    v_add_f32 v56, v72, v16
    v_add_f32 v57, v73, v17
    v_add_f32 v58, v74, v18
    v_add_f32 v59, v75, v19
    v_add_f32 v60, v76, v20
    v_add_f32 v61, v77, v21
    v_add_f32 v62, v78, v22
    v_add_f32 v63, v79, v23
    v_add_f32 v64, v80, v24
    s_branch L_cx
L_c0:
    v_add_f32 v56, v56, v16
    v_add_f32 v57, v57, v17
    v_add_f32 v58, v58, v18
    v_add_f32 v59, v59, v19
    v_add_f32 v60, v60, v20
    v_add_f32 v61, v61, v21
    v_add_f32 v62, v62, v22
    v_add_f32 v63, v63, v23
    v_add_f32 v64, v64, v24
L_cx:
    v_fma_f32 v3, v56, 0, v64
    v_fma_f32 v3, v57, 0, v3
    v_fma_f32 v3, v58, 0, v3
    v_fma_f32 v3, v59, 0, v3
    v_fma_f32 v3, v60, 0, v3
    v_fma_f32 v3, v61, 0, v3
    v_fma_f32 v3, v62, 0, v3
    v_fma_f32 v3, v63, 0, v3
    v_mov_b32 v4, 0x5f800000
    v_cmp_nle_f32 vcc, 0x1f800000, v3
    v_cmp_nle_f32 s[48:49], v3, v4
    s_or_b64 vcc, vcc, s[48:49]
    s_cbranch_vccz L_fast
    s_waitcnt vmcnt(0)
    s_cmp_eq_u32 s57, 0
    s_cbranch_scc1 L_q0
    v_mov_b32 v8, v12
    v_mov_b32 v9, v13
    v_mov_b32 v10, v14
    v_mov_b32 v11, v15
L_q0:
    s_lshl_b32 s48, s44, 2
    s_add_u32 s48, s48, s56
    s_lshl_b32 s48, s48, 16
    s_add_u32 s48, s48, 1048576
    v_mov_b32 v3, 0xff800000
    s_mov_b32 s49, 0
L_max:
    s_add_u32 s50, s48, s49
    buffer_load_dwordx4 v[88:91], v2, s[28:31], s50 offen sc1
    s_waitcnt vmcnt(0)
    v_mfma_f32_32x32x16_bf16 v[16:31], v[88:91], v[8:11], 0
    s_nop 15
    s_nop 3
    v_max3_f32 v3, v3, v16, v17
    v_max3_f32 v3, v3, v18, v19
    v_max3_f32 v3, v3, v20, v21
    v_max3_f32 v3, v3, v22, v23
    v_max3_f32 v3, v3, v24, v25
    v_max3_f32 v3, v3, v26, v27
    v_max3_f32 v3, v3, v28, v29
    v_max3_f32 v3, v3, v30, v31
    s_add_u32 s49, s49, 0x400
    s_cmp_lt_u32 s49, 0x10000
    s_cbranch_scc1 L_max
    v_mov_b32 v4, v3
    s_nop 1
    v_permlane32_swap_b32 v3, v4
    s_nop 1
    v_max_f32 v3, v3, v4
    v_sub_f32 v32, 0, v3
    v_sub_f32 v33, 0, v3
    v_sub_f32 v34, 0, v3
    v_sub_f32 v35, 0, v3
    v_sub_f32 v36, 0, v3
    v_sub_f32 v37, 0, v3
    v_sub_f32 v38, 0, v3
    v_sub_f32 v39, 0, v3
    v_sub_f32 v40, 0, v3
    v_sub_f32 v41, 0, v3
    v_sub_f32 v42, 0, v3
    v_sub_f32 v43, 0, v3
    v_sub_f32 v44, 0, v3
    v_sub_f32 v45, 0, v3
    v_sub_f32 v46, 0, v3
    v_sub_f32 v47, 0, v3
    v_mov_b32 v56, 0
    v_mov_b32 v57, 0
    v_mov_b32 v58, 0
    v_mov_b32 v59, 0
    v_mov_b32 v60, 0
    v_mov_b32 v61, 0
    v_mov_b32 v62, 0
    v_mov_b32 v63, 0
    v_mov_b32 v64, 0
    v_mov_b32 v65, 0
    v_mov_b32 v66, 0
    v_mov_b32 v67, 0
    v_mov_b32 v68, 0
    v_mov_b32 v69, 0
    v_mov_b32 v70, 0
    v_mov_b32 v71, 0
    s_mov_b32 s49, 0
L_sum:
    s_add_u32 s50, s48, s49
    s_add_u32 s51, s50, 2097152
    buffer_load_dwordx4 v[88:91], v2, s[28:31], s50 offen sc1
    s_mov_b64 exec, s[52:53]
    buffer_load_dwordx4 v[104:107], v6, s[28:31], s51 offen sc1
    buffer_load_dwordx4 v[108:111], v6, s[28:31], s51 offen offset:512 sc1
    s_mov_b64 exec, -1
    s_waitcnt vmcnt(0)
    v_mfma_f32_32x32x16_bf16 v[16:31], v[88:91], v[8:11], v[32:47]
    s_nop 15
    s_nop 3
    v_exp_f32 v16, v16
    v_exp_f32 v17, v17
    v_exp_f32 v18, v18
    v_exp_f32 v19, v19
    v_exp_f32 v20, v20
    v_exp_f32 v21, v21
    v_exp_f32 v22, v22
    v_exp_f32 v23, v23
    v_exp_f32 v24, v24
    v_exp_f32 v25, v25
    v_exp_f32 v26, v26
    v_exp_f32 v27, v27
    v_exp_f32 v28, v28
    v_exp_f32 v29, v29
    v_exp_f32 v30, v30
    v_exp_f32 v31, v31
    s_nop 0
    v_cvt_pk_bf16_f32 v48, v16, v17
    v_cvt_pk_bf16_f32 v49, v18, v19
    v_cvt_pk_bf16_f32 v50, v20, v21
    v_cvt_pk_bf16_f32 v51, v22, v23
    v_cvt_pk_bf16_f32 v52, v24, v25
    v_cvt_pk_bf16_f32 v53, v26, v27
    v_cvt_pk_bf16_f32 v54, v28, v29
    v_cvt_pk_bf16_f32 v55, v30, v31
    s_nop 1
    v_mfma_f32_32x32x16_bf16 v[56:71], v[104:107], v[48:51], v[56:71]
    v_mfma_f32_32x32x16_bf16 v[56:71], v[108:111], v[52:55], v[56:71]
    s_add_u32 s49, s49, 0x400
    s_cmp_lt_u32 s49, 0x10000
    s_cbranch_scc1 L_sum
    s_nop 15
    s_nop 3
L_fast:
    v_rcp_f32 v3, v64
    s_lshl_b32 s48, s45, 3
    s_add_u32 s48, s48, s46
    s_lshl_b32 s48, s48, 3
    v_mul_f32 v3, v3, v249
    s_add_u32 s48, s48, s44
    s_lshl_b32 s48, s48, 7
    s_add_u32 s48, s48, 262144
    v_mul_f32 v56, v56, v3
    v_mul_f32 v57, v57, v3
    v_mul_f32 v58, v58, v3
    v_mul_f32 v59, v59, v3
    v_mul_f32 v60, v60, v3
    v_mul_f32 v61, v61, v3
    v_mul_f32 v62, v62, v3
    v_mul_f32 v63, v63, v3
    v_cvt_pk_bf16_f32 v48, v56, v57
    v_cvt_pk_bf16_f32 v49, v58, v59
    v_cvt_pk_bf16_f32 v50, v60, v61
    v_cvt_pk_bf16_f32 v51, v62, v63
    v_min_u32 v48, 0xfffffffe, v48
    v_min_u32 v49, 0xfffffffe, v49
    v_min_u32 v50, 0xfffffffe, v50
    v_min_u32 v51, 0xfffffffe, v51
    buffer_store_dwordx4 v[48:51], v2, s[28:31], s96 offen sc1
    v_mov_b32 v3, s47
    v_mov_b32 v4, 0
    s_mov_b64 exec, 1
    buffer_store_dword v3, v4, s[28:31], s48 offen sc1
    s_mov_b64 exec, -1
    v_add_u32 v96, 65536, v242
    v_add_u32 v97, 65536, v243
    v_add_u32 v98, 131072, v242
    v_add_u32 v99, 131072, v243
    v_add_u32 v100, 65536, v244
    v_add_u32 v101, 65536, v245
    v_add_u32 v102, 131072, v244
    v_add_u32 v103, 131072, v245
    ds_read_b64_tr_b16 v[80:81], v242 offset:0
    ds_read_b64_tr_b16 v[82:83], v242 offset:512
    ds_read_b64_tr_b16 v[84:85], v243 offset:0
    ds_read_b64_tr_b16 v[86:87], v243 offset:512
    v_sub_f32 v7, 1.0, v7
    v_cvt_pk_bf16_f32 v7, v7, v7
    v_lshlrev_b32 v7, 16, v7
    ds_read_b64_tr_b16 v[88:89], v242 offset:8192
    ds_read_b64_tr_b16 v[90:91], v242 offset:8704
    ds_read_b64_tr_b16 v[92:93], v243 offset:8192
    ds_read_b64_tr_b16 v[94:95], v243 offset:8704
    s_waitcnt lgkmcnt(4)
    v_mfma_f32_32x32x16_bf16 v[16:31], v[80:83], v[136:139], 0
    v_mfma_f32_32x32x16_bf16 v[32:47], v[84:87], v[136:139], 0
    ds_read_b64_tr_b16 v[80:81], v242 offset:16384
    ds_read_b64_tr_b16 v[82:83], v242 offset:16896
    ds_read_b64_tr_b16 v[84:85], v243 offset:16384
    ds_read_b64_tr_b16 v[86:87], v243 offset:16896
    s_waitcnt lgkmcnt(4)
    v_mfma_f32_32x32x16_bf16 v[16:31], v[88:91], v[140:143], v[16:31]
    v_mfma_f32_32x32x16_bf16 v[32:47], v[92:95], v[140:143], v[32:47]
    ds_read_b64_tr_b16 v[88:89], v242 offset:24576
    ds_read_b64_tr_b16 v[90:91], v242 offset:25088
    ds_read_b64_tr_b16 v[92:93], v243 offset:24576
    ds_read_b64_tr_b16 v[94:95], v243 offset:25088
    s_waitcnt lgkmcnt(4)
    v_mfma_f32_32x32x16_bf16 v[16:31], v[80:83], v[144:147], v[16:31]
    v_mfma_f32_32x32x16_bf16 v[32:47], v[84:87], v[144:147], v[32:47]
    ds_read_b64_tr_b16 v[80:81], v242 offset:32768
    ds_read_b64_tr_b16 v[82:83], v242 offset:33280
    ds_read_b64_tr_b16 v[84:85], v243 offset:32768
    ds_read_b64_tr_b16 v[86:87], v243 offset:33280
    s_waitcnt lgkmcnt(4)
    v_mfma_f32_32x32x16_bf16 v[16:31], v[88:91], v[148:151], v[16:31]
    v_mfma_f32_32x32x16_bf16 v[32:47], v[92:95], v[148:151], v[32:47]
    s_barrier
    ds_read_b64_tr_b16 v[88:89], v242 offset:40960
    ds_read_b64_tr_b16 v[90:91], v242 offset:41472
    ds_read_b64_tr_b16 v[92:93], v243 offset:40960
    ds_read_b64_tr_b16 v[94:95], v243 offset:41472
    s_waitcnt lgkmcnt(4)
    v_mfma_f32_32x32x16_bf16 v[16:31], v[80:83], v[152:155], v[16:31]
    v_mfma_f32_32x32x16_bf16 v[32:47], v[84:87], v[152:155], v[32:47]
    s_add_u32 m0, s86, 139264
    s_mov_b32 s87, 1114112
    buffer_load_dwordx4 v241, s[16:19], s87 offen lds
    ds_read_b64_tr_b16 v[80:81], v242 offset:49152
    ds_read_b64_tr_b16 v[82:83], v242 offset:49664
    ds_read_b64_tr_b16 v[84:85], v243 offset:49152
    ds_read_b64_tr_b16 v[86:87], v243 offset:49664
    s_waitcnt lgkmcnt(4)
    v_mfma_f32_32x32x16_bf16 v[16:31], v[88:91], v[156:159], v[16:31]
    v_mfma_f32_32x32x16_bf16 v[32:47], v[92:95], v[156:159], v[32:47]
    s_add_u32 m0, s86, 147456
    s_mov_b32 s87, 1179648
    buffer_load_dwordx4 v241, s[16:19], s87 offen lds
    ds_read_b64_tr_b16 v[88:89], v242 offset:57344
    ds_read_b64_tr_b16 v[90:91], v242 offset:57856
    ds_read_b64_tr_b16 v[92:93], v243 offset:57344
    ds_read_b64_tr_b16 v[94:95], v243 offset:57856
    s_waitcnt lgkmcnt(4)
    v_mfma_f32_32x32x16_bf16 v[16:31], v[80:83], v[160:163], v[16:31]
    v_mfma_f32_32x32x16_bf16 v[32:47], v[84:87], v[160:163], v[32:47]
    s_add_u32 m0, s86, 155648
    s_mov_b32 s87, 1245184
    buffer_load_dwordx4 v241, s[16:19], s87 offen lds
    ds_read_b64_tr_b16 v[80:81], v96 offset:0
    ds_read_b64_tr_b16 v[82:83], v96 offset:512
    ds_read_b64_tr_b16 v[84:85], v97 offset:0
    ds_read_b64_tr_b16 v[86:87], v97 offset:512
    s_waitcnt lgkmcnt(4)
    v_mfma_f32_32x32x16_bf16 v[16:31], v[88:91], v[164:167], v[16:31]
    v_mfma_f32_32x32x16_bf16 v[32:47], v[92:95], v[164:167], v[32:47]
    s_add_u32 m0, s86, 0
    s_mov_b32 s87, 1310720
    buffer_load_dwordx4 v241, s[16:19], s87 offen lds
    ds_read_b64_tr_b16 v[88:89], v96 offset:8192
    ds_read_b64_tr_b16 v[90:91], v96 offset:8704
    ds_read_b64_tr_b16 v[92:93], v97 offset:8192
    ds_read_b64_tr_b16 v[94:95], v97 offset:8704
    s_waitcnt lgkmcnt(4)
    v_mfma_f32_32x32x16_bf16 v[16:31], v[80:83], v[168:171], v[16:31]
    v_mfma_f32_32x32x16_bf16 v[32:47], v[84:87], v[168:171], v[32:47]
    s_add_u32 m0, s86, 8192
    s_mov_b32 s87, 1376256
    buffer_load_dwordx4 v241, s[16:19], s87 offen lds
    ds_read_b64_tr_b16 v[80:81], v96 offset:16384
    ds_read_b64_tr_b16 v[82:83], v96 offset:16896
    ds_read_b64_tr_b16 v[84:85], v97 offset:16384
    ds_read_b64_tr_b16 v[86:87], v97 offset:16896
    s_waitcnt lgkmcnt(4)
    v_mfma_f32_32x32x16_bf16 v[16:31], v[88:91], v[172:175], v[16:31]
    v_mfma_f32_32x32x16_bf16 v[32:47], v[92:95], v[172:175], v[32:47]
    s_add_u32 m0, s86, 16384
    s_add_u32 s87, s63, 0
    s_and_b32 s87, s87, 7
    s_lshl_b32 s87, s87, 16
    buffer_load_dwordx4 v241, s[20:23], s87 offen lds
    s_barrier
    ds_read_b64_tr_b16 v[88:89], v96 offset:24576
    ds_read_b64_tr_b16 v[90:91], v96 offset:25088
    ds_read_b64_tr_b16 v[92:93], v97 offset:24576
    ds_read_b64_tr_b16 v[94:95], v97 offset:25088
    s_waitcnt lgkmcnt(4)
    v_mfma_f32_32x32x16_bf16 v[16:31], v[80:83], v[176:179], v[16:31]
    v_mfma_f32_32x32x16_bf16 v[32:47], v[84:87], v[176:179], v[32:47]
    s_add_u32 m0, s86, 24576
    s_add_u32 s87, s63, 1
    s_and_b32 s87, s87, 7
    s_lshl_b32 s87, s87, 16
    buffer_load_dwordx4 v241, s[20:23], s87 offen lds
    ds_read_b64_tr_b16 v[80:81], v96 offset:32768
    ds_read_b64_tr_b16 v[82:83], v96 offset:33280
    ds_read_b64_tr_b16 v[84:85], v97 offset:32768
    ds_read_b64_tr_b16 v[86:87], v97 offset:33280
    s_waitcnt lgkmcnt(4)
    v_mfma_f32_32x32x16_bf16 v[16:31], v[88:91], v[180:183], v[16:31]
    v_mfma_f32_32x32x16_bf16 v[32:47], v[92:95], v[180:183], v[32:47]
    s_add_u32 m0, s86, 32768
    s_add_u32 s87, s63, 2
    s_and_b32 s87, s87, 7
    s_lshl_b32 s87, s87, 16
    buffer_load_dwordx4 v241, s[20:23], s87 offen lds
    ds_read_b64_tr_b16 v[88:89], v96 offset:40960
    ds_read_b64_tr_b16 v[90:91], v96 offset:41472
    ds_read_b64_tr_b16 v[92:93], v97 offset:40960
    ds_read_b64_tr_b16 v[94:95], v97 offset:41472
    s_waitcnt lgkmcnt(4)
    v_mfma_f32_32x32x16_bf16 v[16:31], v[80:83], v[184:187], v[16:31]
    v_mfma_f32_32x32x16_bf16 v[32:47], v[84:87], v[184:187], v[32:47]
    s_add_u32 m0, s86, 40960
    s_add_u32 s87, s63, 3
    s_and_b32 s87, s87, 7
    s_lshl_b32 s87, s87, 16
    buffer_load_dwordx4 v241, s[20:23], s87 offen lds
    ds_read_b64_tr_b16 v[80:81], v96 offset:49152
    ds_read_b64_tr_b16 v[82:83], v96 offset:49664
    ds_read_b64_tr_b16 v[84:85], v97 offset:49152
    ds_read_b64_tr_b16 v[86:87], v97 offset:49664
    s_waitcnt lgkmcnt(4)
    v_mfma_f32_32x32x16_bf16 v[16:31], v[88:91], v[188:191], v[16:31]
    v_mfma_f32_32x32x16_bf16 v[32:47], v[92:95], v[188:191], v[32:47]
    s_add_u32 m0, s86, 49152
    s_add_u32 s87, s63, 4
    s_and_b32 s87, s87, 7
    s_lshl_b32 s87, s87, 16
    buffer_load_dwordx4 v241, s[20:23], s87 offen lds
    s_lshl_b32 s89, s62, 3
    s_add_u32 s89, s89, s46
    s_lshl_b32 s89, s89, 10
    s_add_u32 s89, s89, 262144
    v_lshlrev_b32 v246, 7, v1
    s_mov_b64 exec, 255
    buffer_load_dword v251, v246, s[28:31], s89 offen sc1
    s_mov_b64 exec, -1
    s_lshl_b32 s96, s62, 1
    s_add_u32 s96, s96, s57
    s_lshl_b32 s96, s96, 5
    s_add_u32 s96, s96, s56
    s_lshl_b32 s96, s96, 10
    s_add_u32 s96, s96, 5242880
    ds_read_b64_tr_b16 v[88:89], v96 offset:57344
    ds_read_b64_tr_b16 v[90:91], v96 offset:57856
    ds_read_b64_tr_b16 v[92:93], v97 offset:57344
    ds_read_b64_tr_b16 v[94:95], v97 offset:57856
    s_waitcnt lgkmcnt(4)
    v_mfma_f32_32x32x16_bf16 v[16:31], v[80:83], v[192:195], v[16:31]
    v_mfma_f32_32x32x16_bf16 v[32:47], v[84:87], v[192:195], v[32:47]
    s_add_u32 m0, s86, 57344
    s_add_u32 s87, s63, 5
    s_and_b32 s87, s87, 7
    s_lshl_b32 s87, s87, 16
    buffer_load_dwordx4 v241, s[20:23], s87 offen lds
    s_mul_i32 s48, s46, 8704
    s_add_u32 s48, s48, 81920
    v_add_u32 v104, s48, v2
    s_lshr_b32 s48, s46, 2
    s_mul_i32 s48, s48, 8704
    s_and_b32 s49, s46, 3
    s_lshl_b32 s49, s49, 7
    s_add_u32 s48, s48, s49
    s_add_u32 s48, s48, 81920
    v_and_b32 v3, 7, v1
    v_mul_u32_u24 v105, 1088, v3
    v_lshrrev_b32 v4, 3, v1
    v_lshl_add_u32 v105, v4, 4, v105
    v_add_u32 v105, s48, v105
    v_lshlrev_b32 v106, 10, v4
    v_lshl_add_u32 v106, v3, 4, v106
    s_lshl_b32 s97, s62, 16
    s_lshl_b32 s49, s46, 13
    s_add_u32 s97, s97, s49
    s_lshl_b32 s49, s63, 7
    s_add_u32 s97, s97, s49
    ds_read_b64_tr_b16 v[80:81], v98 offset:0
    ds_read_b64_tr_b16 v[82:83], v98 offset:512
    ds_read_b64_tr_b16 v[84:85], v99 offset:0
    ds_read_b64_tr_b16 v[86:87], v99 offset:512
    s_waitcnt lgkmcnt(4)
    v_mfma_f32_32x32x16_bf16 v[16:31], v[88:91], v[196:199], v[16:31]
    v_mfma_f32_32x32x16_bf16 v[32:47], v[92:95], v[196:199], v[32:47]
    s_add_u32 m0, s86, 65536
    s_add_u32 s87, s63, 6
    s_and_b32 s87, s87, 7
    s_lshl_b32 s87, s87, 16
    buffer_load_dwordx4 v241, s[20:23], s87 offen lds
    s_waitcnt vmcnt(8)
    s_barrier
    ds_read_b64_tr_b16 v[88:89], v98 offset:8192
    ds_read_b64_tr_b16 v[90:91], v98 offset:8704
    ds_read_b64_tr_b16 v[92:93], v99 offset:8192
    ds_read_b64_tr_b16 v[94:95], v99 offset:8704
    s_waitcnt lgkmcnt(4)
    v_mfma_f32_32x32x16_bf16 v[16:31], v[80:83], v[200:203], v[16:31]
    v_mfma_f32_32x32x16_bf16 v[32:47], v[84:87], v[200:203], v[32:47]
    s_add_u32 m0, s86, 73728
    s_add_u32 s87, s63, 7
    s_and_b32 s87, s87, 7
    s_lshl_b32 s87, s87, 16
    buffer_load_dwordx4 v241, s[20:23], s87 offen lds
    s_waitcnt vmcnt(3)
    s_mov_b64 exec, 255
    v_cmp_ne_u32 vcc, s47, v251
    s_cbranch_vccz L_polled_o
    s_mov_b32 s84, 0
L_poll_o:
    s_sleep 1
    buffer_load_dword v251, v246, s[28:31], s89 offen sc1
    s_add_u32 s84, s84, 1
    s_waitcnt vmcnt(0)
    v_cmp_ne_u32 vcc, s47, v251
    s_cmp_ge_u32 s84, 400000
    s_cbranch_scc1 L_polled_o
    s_cbranch_vccnz L_poll_o
L_polled_o:
    s_mov_b64 exec, -1
    s_add_u32 s49, s63, 0
    s_and_b32 s49, s49, 7
    s_lshl_b32 s49, s49, 12
    s_add_u32 s49, s49, s96
    buffer_load_dwordx4 v[136:139], v2, s[28:31], s49 offen sc1
    s_add_u32 s49, s63, 1
    s_and_b32 s49, s49, 7
    s_lshl_b32 s49, s49, 12
    s_add_u32 s49, s49, s96
    buffer_load_dwordx4 v[140:143], v2, s[28:31], s49 offen sc1
    s_add_u32 s49, s63, 2
    s_and_b32 s49, s49, 7
    s_lshl_b32 s49, s49, 12
    s_add_u32 s49, s49, s96
    buffer_load_dwordx4 v[144:147], v2, s[28:31], s49 offen sc1
    s_add_u32 s49, s63, 3
    s_and_b32 s49, s49, 7
    s_lshl_b32 s49, s49, 12
    s_add_u32 s49, s49, s96
    buffer_load_dwordx4 v[148:151], v2, s[28:31], s49 offen sc1
    s_add_u32 s49, s63, 4
    s_and_b32 s49, s49, 7
    s_lshl_b32 s49, s49, 12
    s_add_u32 s49, s49, s96
    buffer_load_dwordx4 v[152:155], v2, s[28:31], s49 offen sc1
    s_add_u32 s49, s63, 5
    s_and_b32 s49, s49, 7
    s_lshl_b32 s49, s49, 12
    s_add_u32 s49, s49, s96
    buffer_load_dwordx4 v[156:159], v2, s[28:31], s49 offen sc1
    s_add_u32 s49, s63, 6
    s_and_b32 s49, s49, 7
    s_lshl_b32 s49, s49, 12
    s_add_u32 s49, s49, s96
    buffer_load_dwordx4 v[160:163], v2, s[28:31], s49 offen sc1
    s_add_u32 s49, s63, 7
    s_and_b32 s49, s49, 7
    s_lshl_b32 s49, s49, 12
    s_add_u32 s49, s49, s96
    buffer_load_dwordx4 v[164:167], v2, s[28:31], s49 offen sc1
    ds_read_b64_tr_b16 v[80:81], v98 offset:16384
    ds_read_b64_tr_b16 v[82:83], v98 offset:16896
    ds_read_b64_tr_b16 v[84:85], v99 offset:16384
    ds_read_b64_tr_b16 v[86:87], v99 offset:16896
    s_waitcnt lgkmcnt(4)
    v_mfma_f32_32x32x16_bf16 v[16:31], v[88:91], v[204:207], v[16:31]
    v_mfma_f32_32x32x16_bf16 v[32:47], v[92:95], v[204:207], v[32:47]
    ds_read_b64_tr_b16 v[88:89], v98 offset:24576
    ds_read_b64_tr_b16 v[90:91], v98 offset:25088
    ds_read_b64_tr_b16 v[92:93], v99 offset:24576
    ds_read_b64_tr_b16 v[94:95], v99 offset:25088
    s_waitcnt lgkmcnt(4)
    v_mfma_f32_32x32x16_bf16 v[16:31], v[80:83], v[208:211], v[16:31]
    v_mfma_f32_32x32x16_bf16 v[32:47], v[84:87], v[208:211], v[32:47]
    ds_read_b64_tr_b16 v[80:81], v242 offset:0
    ds_read_b64_tr_b16 v[82:83], v242 offset:512
    ds_read_b64_tr_b16 v[84:85], v243 offset:0
    ds_read_b64_tr_b16 v[86:87], v243 offset:512
    s_waitcnt lgkmcnt(4)
    v_mfma_f32_32x32x16_bf16 v[16:31], v[88:91], v[212:215], v[16:31]
    v_mfma_f32_32x32x16_bf16 v[32:47], v[92:95], v[212:215], v[32:47]
    ds_read_b64_tr_b16 v[88:89], v242 offset:8192
    ds_read_b64_tr_b16 v[90:91], v242 offset:8704
    ds_read_b64_tr_b16 v[92:93], v243 offset:8192
    ds_read_b64_tr_b16 v[94:95], v243 offset:8704
    s_waitcnt lgkmcnt(4)
    v_mfma_f32_32x32x16_bf16 v[16:31], v[80:83], v[216:219], v[16:31]
    v_mfma_f32_32x32x16_bf16 v[32:47], v[84:87], v[216:219], v[32:47]
    s_waitcnt lgkmcnt(0)
    s_cmp_ge_u32 s56, 2
    s_cbranch_scc1 L_skip21
    v_mfma_f32_32x32x16_bf16 v[16:31], v[88:91], v[220:223], v[16:31]
    v_mfma_f32_32x32x16_bf16 v[32:47], v[92:95], v[220:223], v[32:47]
L_skip21:
    s_waitcnt vmcnt(8)
    s_barrier
    ds_read_b64_tr_b16 v[80:81], v244 offset:16384
    ds_read_b64_tr_b16 v[82:83], v244 offset:17408
    ds_read_b64_tr_b16 v[84:85], v245 offset:16384
    ds_read_b64_tr_b16 v[86:87], v245 offset:17408
    s_mov_b32 s84, 0
    s_nop 3
    v_mul_f32 v16, v16, v7
    v_mul_f32 v17, v17, v7
    v_mul_f32 v18, v18, v7
    v_mul_f32 v19, v19, v7
    v_mul_f32 v20, v20, v7
    v_mul_f32 v21, v21, v7
    v_mul_f32 v22, v22, v7
    v_mul_f32 v23, v23, v7
    v_mul_f32 v24, v24, v7
    v_mul_f32 v25, v25, v7
    v_mul_f32 v26, v26, v7
    v_mul_f32 v27, v27, v7
    v_mul_f32 v28, v28, v7
    v_mul_f32 v29, v29, v7
    v_mul_f32 v30, v30, v7
    v_mul_f32 v31, v31, v7
    v_mul_f32 v32, v32, v7
    v_mul_f32 v33, v33, v7
    v_mul_f32 v34, v34, v7
    v_mul_f32 v35, v35, v7
    v_mul_f32 v36, v36, v7
    v_mul_f32 v37, v37, v7
    v_mul_f32 v38, v38, v7
    v_mul_f32 v39, v39, v7
    v_mul_f32 v40, v40, v7
    v_mul_f32 v41, v41, v7
    v_mul_f32 v42, v42, v7
    v_mul_f32 v43, v43, v7
    v_mul_f32 v44, v44, v7
    v_mul_f32 v45, v45, v7
    v_mul_f32 v46, v46, v7
    v_mul_f32 v47, v47, v7
    ds_read_b64_tr_b16 v[88:89], v244 offset:24576
    ds_read_b64_tr_b16 v[90:91], v244 offset:25600
    ds_read_b64_tr_b16 v[92:93], v245 offset:24576
    ds_read_b64_tr_b16 v[94:95], v245 offset:25600
    s_waitcnt vmcnt(7)
L_ochk0:
    v_max3_u32 v3, v136, v137, v138
    v_max_u32 v3, v3, v139
    v_cmp_eq_u32 vcc, -1, v3
    s_cbranch_vccnz L_oretry0
L_ook0:
    s_waitcnt lgkmcnt(4)
    v_mfma_f32_32x32x16_bf16 v[16:31], v[80:83], v[136:139], v[16:31]
    v_mfma_f32_32x32x16_bf16 v[32:47], v[84:87], v[136:139], v[32:47]
    ds_read_b64_tr_b16 v[80:81], v244 offset:32768
    ds_read_b64_tr_b16 v[82:83], v244 offset:33792
    ds_read_b64_tr_b16 v[84:85], v245 offset:32768
    ds_read_b64_tr_b16 v[86:87], v245 offset:33792
    s_waitcnt vmcnt(6)
L_ochk1:
    v_max3_u32 v3, v140, v141, v142
    v_max_u32 v3, v3, v143
    v_cmp_eq_u32 vcc, -1, v3
    s_cbranch_vccnz L_oretry1
L_ook1:
    s_waitcnt lgkmcnt(4)
    v_mfma_f32_32x32x16_bf16 v[16:31], v[88:91], v[140:143], v[16:31]
    v_mfma_f32_32x32x16_bf16 v[32:47], v[92:95], v[140:143], v[32:47]
    ds_read_b64_tr_b16 v[88:89], v244 offset:40960
    ds_read_b64_tr_b16 v[90:91], v244 offset:41984
    ds_read_b64_tr_b16 v[92:93], v245 offset:40960
    ds_read_b64_tr_b16 v[94:95], v245 offset:41984
    s_waitcnt vmcnt(5)
L_ochk2:
    v_max3_u32 v3, v144, v145, v146
    v_max_u32 v3, v3, v147
    v_cmp_eq_u32 vcc, -1, v3
    s_cbranch_vccnz L_oretry2
L_ook2:
    s_waitcnt lgkmcnt(4)
    v_mfma_f32_32x32x16_bf16 v[16:31], v[80:83], v[144:147], v[16:31]
    v_mfma_f32_32x32x16_bf16 v[32:47], v[84:87], v[144:147], v[32:47]
    ds_read_b64_tr_b16 v[80:81], v244 offset:49152
    ds_read_b64_tr_b16 v[82:83], v244 offset:50176
    ds_read_b64_tr_b16 v[84:85], v245 offset:49152
    ds_read_b64_tr_b16 v[86:87], v245 offset:50176
    s_waitcnt vmcnt(4)
L_ochk3:
    v_max3_u32 v3, v148, v149, v150
    v_max_u32 v3, v3, v151
    v_cmp_eq_u32 vcc, -1, v3
    s_cbranch_vccnz L_oretry3
L_ook3:
    s_waitcnt lgkmcnt(4)
    v_mfma_f32_32x32x16_bf16 v[16:31], v[88:91], v[148:151], v[16:31]
    v_mfma_f32_32x32x16_bf16 v[32:47], v[92:95], v[148:151], v[32:47]
    ds_read_b64_tr_b16 v[88:89], v244 offset:57344
    ds_read_b64_tr_b16 v[90:91], v244 offset:58368
    ds_read_b64_tr_b16 v[92:93], v245 offset:57344
    ds_read_b64_tr_b16 v[94:95], v245 offset:58368
    s_waitcnt vmcnt(3)
L_ochk4:
    v_max3_u32 v3, v152, v153, v154
    v_max_u32 v3, v3, v155
    v_cmp_eq_u32 vcc, -1, v3
    s_cbranch_vccnz L_oretry4
L_ook4:
    s_waitcnt lgkmcnt(4)
    v_mfma_f32_32x32x16_bf16 v[16:31], v[80:83], v[152:155], v[16:31]
    v_mfma_f32_32x32x16_bf16 v[32:47], v[84:87], v[152:155], v[32:47]
    ds_read_b64_tr_b16 v[80:81], v100 offset:0
    ds_read_b64_tr_b16 v[82:83], v100 offset:1024
    ds_read_b64_tr_b16 v[84:85], v101 offset:0
    ds_read_b64_tr_b16 v[86:87], v101 offset:1024
    s_waitcnt vmcnt(2)
L_ochk5:
    v_max3_u32 v3, v156, v157, v158
    v_max_u32 v3, v3, v159
    v_cmp_eq_u32 vcc, -1, v3
    s_cbranch_vccnz L_oretry5
L_ook5:
    s_waitcnt lgkmcnt(4)
    v_mfma_f32_32x32x16_bf16 v[16:31], v[88:91], v[156:159], v[16:31]
    v_mfma_f32_32x32x16_bf16 v[32:47], v[92:95], v[156:159], v[32:47]
    ds_read_b64_tr_b16 v[88:89], v100 offset:8192
    ds_read_b64_tr_b16 v[90:91], v100 offset:9216
    ds_read_b64_tr_b16 v[92:93], v101 offset:8192
    ds_read_b64_tr_b16 v[94:95], v101 offset:9216
    s_waitcnt vmcnt(1)
L_ochk6:
    v_max3_u32 v3, v160, v161, v162
    v_max_u32 v3, v3, v163
    v_cmp_eq_u32 vcc, -1, v3
    s_cbranch_vccnz L_oretry6
L_ook6:
    s_waitcnt lgkmcnt(4)
    v_mfma_f32_32x32x16_bf16 v[16:31], v[80:83], v[160:163], v[16:31]
    v_mfma_f32_32x32x16_bf16 v[32:47], v[84:87], v[160:163], v[32:47]
    s_waitcnt vmcnt(0)
L_ochk7:
    v_max3_u32 v3, v164, v165, v166
    v_max_u32 v3, v3, v167
    v_cmp_eq_u32 vcc, -1, v3
    s_cbranch_vccnz L_oretry7
L_ook7:
    s_waitcnt lgkmcnt(0)
    v_mfma_f32_32x32x16_bf16 v[16:31], v[88:91], v[164:167], v[16:31]
    v_mfma_f32_32x32x16_bf16 v[32:47], v[92:95], v[164:167], v[32:47]
    s_nop 11
    ds_write_b128 v104, v[16:19] offset:0
    ds_write_b128 v104, v[20:23] offset:1088
    ds_write_b128 v104, v[24:27] offset:2176
    ds_write_b128 v104, v[28:31] offset:3264
    ds_write_b128 v104, v[32:35] offset:4352
    ds_write_b128 v104, v[36:39] offset:5440
    ds_write_b128 v104, v[40:43] offset:6528
    ds_write_b128 v104, v[44:47] offset:7616
    s_waitcnt lgkmcnt(0)
    s_barrier
    ds_read_b128 v[48:51], v105 offset:0
    ds_read_b128 v[52:55], v105 offset:512
    ds_read_b128 v[56:59], v105 offset:17408
    ds_read_b128 v[60:63], v105 offset:17920
    ds_read_b128 v[64:67], v105 offset:34816
    ds_read_b128 v[68:71], v105 offset:35328
    ds_read_b128 v[72:75], v105 offset:52224
    ds_read_b128 v[76:79], v105 offset:52736
    s_waitcnt lgkmcnt(4)
    v_add_f32 v48, v48, v56
    v_add_f32 v49, v49, v57
    v_add_f32 v50, v50, v58
    v_add_f32 v51, v51, v59
    v_add_f32 v52, v52, v60
    v_add_f32 v53, v53, v61
    v_add_f32 v54, v54, v62
    v_add_f32 v55, v55, v63
    s_waitcnt lgkmcnt(0)
    v_add_f32 v64, v64, v72
    v_add_f32 v65, v65, v73
    v_add_f32 v66, v66, v74
    v_add_f32 v67, v67, v75
    v_add_f32 v68, v68, v76
    v_add_f32 v69, v69, v77
    v_add_f32 v70, v70, v78
    v_add_f32 v71, v71, v79
    v_add_f32 v48, v48, v64
    v_add_f32 v49, v49, v65
    v_add_f32 v50, v50, v66
    v_add_f32 v51, v51, v67
    v_add_f32 v52, v52, v68
    v_add_f32 v53, v53, v69
    v_add_f32 v54, v54, v70
    v_add_f32 v55, v55, v71
    v_cvt_pk_bf16_f32 v16, v48, v49
    v_cvt_pk_bf16_f32 v17, v50, v51
    v_cvt_pk_bf16_f32 v18, v52, v53
    v_cvt_pk_bf16_f32 v19, v54, v55
    buffer_store_dwordx4 v[16:19], v106, s[24:27], s97 offen
    s_cmp_lg_u32 s2, 0
    s_cbranch_scc1 L_noepoch
    s_cmp_lg_u32 s46, 0
    s_cbranch_scc1 L_noepoch
    s_mov_b32 s48, 0
    v_mov_b32 v3, s47
    v_mov_b32 v4, 0
    s_mov_b64 exec, 1
    buffer_store_dword v3, v4, s[28:31], s48 offen sc1
    s_mov_b64 exec, -1
L_noepoch:
L_end:
    s_endpgm
L_oretry0:
    s_add_u32 s84, s84, 1
    s_cmp_ge_u32 s84, 400000
    s_cbranch_scc1 L_ook0
    s_sleep 2
    s_add_u32 s49, s63, 0
    s_and_b32 s49, s49, 7
    s_lshl_b32 s49, s49, 12
    s_add_u32 s49, s49, s96
    buffer_load_dwordx4 v[136:139], v2, s[28:31], s49 offen sc1
    s_waitcnt vmcnt(0)
    s_branch L_ochk0
L_oretry1:
    s_add_u32 s84, s84, 1
    s_cmp_ge_u32 s84, 400000
    s_cbranch_scc1 L_ook1
    s_sleep 2
    s_add_u32 s49, s63, 1
    s_and_b32 s49, s49, 7
    s_lshl_b32 s49, s49, 12
    s_add_u32 s49, s49, s96
    buffer_load_dwordx4 v[140:143], v2, s[28:31], s49 offen sc1
    s_waitcnt vmcnt(0)
    s_branch L_ochk1
L_oretry2:
    s_add_u32 s84, s84, 1
    s_cmp_ge_u32 s84, 400000
    s_cbranch_scc1 L_ook2
    s_sleep 2
    s_add_u32 s49, s63, 2
    s_and_b32 s49, s49, 7
    s_lshl_b32 s49, s49, 12
    s_add_u32 s49, s49, s96
    buffer_load_dwordx4 v[144:147], v2, s[28:31], s49 offen sc1
    s_waitcnt vmcnt(0)
    s_branch L_ochk2
L_oretry3:
    s_add_u32 s84, s84, 1
    s_cmp_ge_u32 s84, 400000
    s_cbranch_scc1 L_ook3
    s_sleep 2
    s_add_u32 s49, s63, 3
    s_and_b32 s49, s49, 7
    s_lshl_b32 s49, s49, 12
    s_add_u32 s49, s49, s96
    buffer_load_dwordx4 v[148:151], v2, s[28:31], s49 offen sc1
    s_waitcnt vmcnt(0)
    s_branch L_ochk3
L_oretry4:
    s_add_u32 s84, s84, 1
    s_cmp_ge_u32 s84, 400000
    s_cbranch_scc1 L_ook4
    s_sleep 2
    s_add_u32 s49, s63, 4
    s_and_b32 s49, s49, 7
    s_lshl_b32 s49, s49, 12
    s_add_u32 s49, s49, s96
    buffer_load_dwordx4 v[152:155], v2, s[28:31], s49 offen sc1
    s_waitcnt vmcnt(0)
    s_branch L_ochk4
L_oretry5:
    s_add_u32 s84, s84, 1
    s_cmp_ge_u32 s84, 400000
    s_cbranch_scc1 L_ook5
    s_sleep 2
    s_add_u32 s49, s63, 5
    s_and_b32 s49, s49, 7
    s_lshl_b32 s49, s49, 12
    s_add_u32 s49, s49, s96
    buffer_load_dwordx4 v[156:159], v2, s[28:31], s49 offen sc1
    s_waitcnt vmcnt(0)
    s_branch L_ochk5
L_oretry6:
    s_add_u32 s84, s84, 1
    s_cmp_ge_u32 s84, 400000
    s_cbranch_scc1 L_ook6
    s_sleep 2
    s_add_u32 s49, s63, 6
    s_and_b32 s49, s49, 7
    s_lshl_b32 s49, s49, 12
    s_add_u32 s49, s49, s96
    buffer_load_dwordx4 v[160:163], v2, s[28:31], s49 offen sc1
    s_waitcnt vmcnt(0)
    s_branch L_ochk6
L_oretry7:
    s_add_u32 s84, s84, 1
    s_cmp_ge_u32 s84, 400000
    s_cbranch_scc1 L_ook7
    s_sleep 2
    s_add_u32 s49, s63, 7
    s_and_b32 s49, s49, 7
    s_lshl_b32 s49, s49, 12
    s_add_u32 s49, s49, s96
    buffer_load_dwordx4 v[164:167], v2, s[28:31], s49 offen sc1
    s_waitcnt vmcnt(0)
    s_branch L_ochk7
L_code_end:

.section .rodata,"a"
.p2align 6
.amdhsa_kernel gated_mix__mha_block__dense_activation_silu__prompt_kernel
  .amdhsa_next_free_vgpr 256
  .amdhsa_next_free_sgpr 102
  .amdhsa_accum_offset 256
  .amdhsa_group_segment_fixed_size 0
  .amdhsa_kernarg_size 80
  .amdhsa_user_sgpr_count 2
  .amdhsa_user_sgpr_kernarg_segment_ptr 1
  .amdhsa_system_sgpr_workgroup_id_x 1
  .amdhsa_float_denorm_mode_32 3
.end_amdhsa_kernel
```
